```python
import torch

def _softmax(x, axis=-1):
    return torch.softmax(x, dim=axis)
def _gelu(x):
    return torch.nn.functional.gelu(x, approximate="tanh")
def _silu(x):
    return torch.nn.functional.silu(x)
def _sigmoid(x):
    return torch.sigmoid(x)
def _layernorm(x, axis=-1, eps=1e-5):
    m = x.mean(dim=axis, keepdim=True)
    v = x.var(dim=axis, keepdim=True, unbiased=False)
    return (x - m) / torch.sqrt(v + eps)
def _scatter_add(tgt, idx, src, axis=0):
    return tgt.clone().index_add_(axis, idx, src)
def _segment_sum(src, seg, n):
    out = torch.zeros((n,) + src.shape[1:], dtype=src.dtype)
    return out.index_add_(0, seg, src)
def _pad(x, pw):
    flat = tuple(v for pair in reversed(pw) for v in pair)
    return torch.nn.functional.pad(x, flat)

kernel_name = 'standalone__cheap_equivariant_egnn__graph'

def setup_inputs():

    _w = (lambda a: (lambda t: t.to(torch.bfloat16) if t.is_floating_point() else t)(torch.as_tensor(a)))
    N, deg, D, De = 10000, 16, 128, max(4, 1)
    E = N * deg
    return {
        "h": _w((lambda *s: torch.randn(*s, dtype=torch.bfloat16) * 0.2)(N, D)),
        "pos": _w((lambda *s: torch.randn(*s, dtype=torch.bfloat16) * 0.8)(N, 3)),
        "e_attr": _w((lambda *s: torch.randn(*s, dtype=torch.bfloat16) * 0.8)(E, De)),
        "src": _w((lambda lo, hi, *s: torch.randint(lo, hi, s))(0, N, E).to(torch.int64)),
        "dst": _w((lambda lo, hi, *s: torch.randint(lo, hi, s))(0, N, E).to(torch.int64)),
        "w_e": _w(0.1 * (lambda *s: torch.randn(*s, dtype=torch.bfloat16) * 0.8)(2 * D + 1 + De, D)),
        "w_x": _w(0.1 * (lambda *s: torch.randn(*s, dtype=torch.bfloat16) * 0.2)(D, 1)),
        "w_h": _w(0.1 * (lambda *s: torch.randn(*s, dtype=torch.bfloat16) * 0.2)(2 * D, D)),
    }

def reference(h, pos, e_attr, src, dst, w_e, w_x, w_h):
    N, D = h.shape[0], h.shape[1]
    diff = pos[dst] - pos[src]
    dist2 = torch.sum(diff * diff, axis=-1, keepdims=True)
    e_in = torch.concatenate([h[dst], h[src], dist2, e_attr], axis=-1)
    m_ij = _silu(e_in @ w_e)
    coord_scale = m_ij @ w_x
    pos_new = pos + _segment_sum(diff * coord_scale, dst, N)
    m_i = _segment_sum(m_ij, dst, N)
    h_new = h + _silu(torch.concatenate([h, m_i], axis=-1) @ w_h)
    return h_new, pos_new
```

```asm
; @launch kernel=egnn_prep_kernel grid=(230,1,1) block=(512,1,1) lds=81920
; @launch kernel=egnn_main_kernel grid=(250,1,1) block=(512,1,1) lds=162688
.amdgcn_target "amdgcn-amd-amdhsa--gfx950"
.text
.globl egnn_prep_kernel
.p2align 8
.type egnn_prep_kernel,@function
egnn_prep_kernel:
    s_load_dwordx16 s[4:19], s[0:1], 0
    s_load_dwordx2 s[20:21], s[0:1], 80
    s_cmp_lt_u32 s2, 64
    s_cbranch_scc1 .K1_BIN
    s_cmp_lt_u32 s2, 221
    s_cbranch_scc1 .K1_GEMM
    s_cmp_lt_u32 s2, 229
    s_cbranch_scc1 .K1_WPREP
    s_cmp_eq_u32 s2, 229
    s_cbranch_scc1 .K1_WSM
    s_endpgm
.K1_BIN:
    v_lshlrev_b32 v2, 2, v0
    v_lshlrev_b32 v3, 3, v0
    s_mul_i32 s40, s2, 10000
    s_add_u32 s41, s40, 4096
    s_add_u32 s42, s40, 8192
    s_mul_i32 s43, s2, 20000
    s_add_u32 s44, s43, 4096
    s_add_u32 s45, s43, 8192
    s_add_u32 s46, s43, 12288
    s_add_u32 s47, s43, 16384
    s_waitcnt lgkmcnt(0)
    s_mov_b32 s24, s12
    s_mov_b32 s25, s13
    s_mov_b32 s26, 640000
    s_mov_b32 s27, 0x00020000
    s_mov_b32 s28, s10
    s_mov_b32 s29, s11
    s_mov_b32 s30, 640000
    s_mov_b32 s31, 0x00020000
    s_mov_b32 s32, s8
    s_mov_b32 s33, s9
    s_mov_b32 s34, 1280000
    s_mov_b32 s35, 0x00020000
    s_mov_b32 s36, s20
    s_mov_b32 s37, s21
    s_mov_b32 s38, 11534336
    s_mov_b32 s39, 0x00020000
    buffer_load_dword v10, v2, s[24:27], s40 offen offset:0
    buffer_load_dword v11, v2, s[24:27], s40 offen offset:2048
    buffer_load_dword v12, v2, s[24:27], s41 offen offset:0
    buffer_load_dword v13, v2, s[24:27], s41 offen offset:2048
    buffer_load_dword v14, v2, s[24:27], s42 offen offset:0
    buffer_load_dword v15, v2, s[28:31], s40 offen offset:0
    buffer_load_dword v16, v2, s[28:31], s40 offen offset:2048
    buffer_load_dword v17, v2, s[28:31], s41 offen offset:0
    buffer_load_dword v18, v2, s[28:31], s41 offen offset:2048
    buffer_load_dword v19, v2, s[28:31], s42 offen offset:0
    buffer_load_dwordx2 v[20:21], v3, s[32:35], s43 offen
    buffer_load_dwordx2 v[22:23], v3, s[32:35], s44 offen
    buffer_load_dwordx2 v[24:25], v3, s[32:35], s45 offen
    buffer_load_dwordx2 v[26:27], v3, s[32:35], s46 offen
    buffer_load_dwordx2 v[28:29], v3, s[32:35], s47 offen
    v_lshlrev_b32 v1, 4, v0
    v_mov_b32 v4, -1
    v_mov_b32 v5, -1
    v_mov_b32 v6, -1
    v_mov_b32 v7, -1
    v_mov_b32 v8, 0
    v_mov_b32 v9, 1
    ds_write_b32 v2, v8
    ds_write_b128 v1, v[4:7] offset:2048
    ds_write_b128 v1, v[4:7] offset:10240
    ds_write_b128 v1, v[4:7] offset:18432
    s_movk_i32 s50, 452
    v_cmp_gt_u32 s[48:49], s50, v0
    v_cmp_gt_u32 s[84:85], 40, v0
    s_movk_i32 s50, 80
    v_cmp_gt_u32 s[86:87], s50, v0
    v_lshrrev_b32 v4, 2, v0
    v_and_b32 v5, 3, v0
    v_lshlrev_b32 v5, 4, v5
    v_lshl_add_u32 v6, v4, 12, v5
    v_lshrrev_b32 v4, 3, v0
    v_and_b32 v5, 7, v0
    v_lshlrev_b32 v5, 4, v5
    v_lshl_add_u32 v7, v4, 13, v5
    s_lshl_b32 s76, s2, 6
    s_add_u32 s76, s76, 3145728
    s_add_u32 s77, s76, 524288
    s_add_u32 s83, s76, 1048576
    s_lshl_b32 s78, s2, 7
    s_add_u32 s78, s78, 4259840
    s_add_u32 s79, s78, 524288
    s_add_u32 s80, s78, 1048576
    s_add_u32 s81, s78, 1572864
    s_add_u32 s82, s78, 2097152
    s_waitcnt lgkmcnt(0)
    s_barrier
    s_waitcnt vmcnt(10)
    v_mul_u32_u24 v30, 13108, v10
    v_lshrrev_b32 v35, 17, v30
    v_and_b32 v35, 0x3fc, v35
    ds_add_rtn_u32 v40, v35, v9
    v_mul_u32_u24 v31, 13108, v11
    v_lshrrev_b32 v36, 17, v31
    v_and_b32 v36, 0x3fc, v36
    ds_add_rtn_u32 v41, v36, v9
    v_mul_u32_u24 v32, 13108, v12
    v_lshrrev_b32 v37, 17, v32
    v_and_b32 v37, 0x3fc, v37
    ds_add_rtn_u32 v42, v37, v9
    v_mul_u32_u24 v33, 13108, v13
    v_lshrrev_b32 v38, 17, v33
    v_and_b32 v38, 0x3fc, v38
    ds_add_rtn_u32 v43, v38, v9
    v_mul_u32_u24 v34, 13108, v14
    v_lshrrev_b32 v39, 17, v34
    v_and_b32 v39, 0x3fc, v39
    s_mov_b64 exec, s[48:49]
    ds_add_rtn_u32 v44, v39, v9
    s_mov_b64 exec, -1
    v_lshrrev_b32 v30, 16, v30
    v_mad_i32_i24 v55, v30, -5, v10
    v_lshlrev_b32 v56, 2, v30
    v_and_b32 v56, 0x1c, v56
    v_lshl_or_b32 v55, v55, 5, v56
    v_lshl_or_b32 v50, v35, 20, v55
    v_lshrrev_b32 v31, 16, v31
    v_mad_i32_i24 v55, v31, -5, v11
    v_lshlrev_b32 v56, 2, v31
    v_and_b32 v56, 0x1c, v56
    v_lshl_or_b32 v55, v55, 5, v56
    v_lshl_or_b32 v51, v36, 20, v55
    v_lshrrev_b32 v32, 16, v32
    v_mad_i32_i24 v55, v32, -5, v12
    v_lshlrev_b32 v56, 2, v32
    v_and_b32 v56, 0x1c, v56
    v_lshl_or_b32 v55, v55, 5, v56
    v_lshl_or_b32 v52, v37, 20, v55
    v_lshrrev_b32 v33, 16, v33
    v_mad_i32_i24 v55, v33, -5, v13
    v_lshlrev_b32 v56, 2, v33
    v_and_b32 v56, 0x1c, v56
    v_lshl_or_b32 v55, v55, 5, v56
    v_lshl_or_b32 v53, v38, 20, v55
    v_lshrrev_b32 v34, 16, v34
    v_mad_i32_i24 v55, v34, -5, v14
    v_lshlrev_b32 v56, 2, v34
    v_and_b32 v56, 0x1c, v56
    v_lshl_or_b32 v55, v55, 5, v56
    v_lshl_or_b32 v54, v39, 20, v55
    s_waitcnt vmcnt(5)
    v_lshl_or_b32 v50, v15, 8, v50
    v_lshl_or_b32 v51, v16, 8, v51
    v_lshl_or_b32 v52, v17, 8, v52
    v_lshl_or_b32 v53, v18, 8, v53
    v_lshl_or_b32 v54, v19, 8, v54
    s_waitcnt vmcnt(0) lgkmcnt(0)
    v_cmp_gt_u32 s[52:53], 16, v40
    v_lshlrev_b32 v55, 2, v40
    v_lshl_add_u32 v55, v35, 4, v55
    v_lshlrev_b32 v56, 1, v55
    s_not_b64 s[62:63], s[52:53]
    s_mov_b64 exec, s[52:53]
    ds_write_b32 v55, v50 offset:2048
    ds_write_b64 v56, v[20:21] offset:26624
    s_mov_b64 exec, -1
    v_cmp_gt_u32 s[54:55], 16, v41
    v_lshlrev_b32 v55, 2, v41
    v_lshl_add_u32 v55, v36, 4, v55
    v_lshlrev_b32 v56, 1, v55
    s_not_b64 s[64:65], s[54:55]
    s_mov_b64 exec, s[54:55]
    ds_write_b32 v55, v51 offset:2048
    ds_write_b64 v56, v[22:23] offset:26624
    s_mov_b64 exec, -1
    v_cmp_gt_u32 s[56:57], 16, v42
    v_lshlrev_b32 v55, 2, v42
    v_lshl_add_u32 v55, v37, 4, v55
    v_lshlrev_b32 v56, 1, v55
    s_not_b64 s[66:67], s[56:57]
    s_mov_b64 exec, s[56:57]
    ds_write_b32 v55, v52 offset:2048
    ds_write_b64 v56, v[24:25] offset:26624
    s_mov_b64 exec, -1
    v_cmp_gt_u32 s[58:59], 16, v43
    v_lshlrev_b32 v55, 2, v43
    v_lshl_add_u32 v55, v38, 4, v55
    v_lshlrev_b32 v56, 1, v55
    s_not_b64 s[68:69], s[58:59]
    s_mov_b64 exec, s[58:59]
    ds_write_b32 v55, v53 offset:2048
    ds_write_b64 v56, v[26:27] offset:26624
    s_mov_b64 exec, -1
    v_cmp_gt_u32 s[60:61], 16, v44
    v_lshlrev_b32 v55, 2, v44
    v_lshl_add_u32 v55, v39, 4, v55
    v_lshlrev_b32 v56, 1, v55
    s_andn2_b64 s[70:71], s[48:49], s[60:61]
    s_and_b64 exec, s[48:49], s[60:61]
    ds_write_b32 v55, v54 offset:2048
    ds_write_b64 v56, v[28:29] offset:26624
    s_mov_b64 exec, -1
    s_or_b64 s[72:73], s[62:63], s[64:65]
    s_or_b64 s[74:75], s[66:67], s[68:69]
    s_or_b64 s[72:73], s[72:73], s[70:71]
    s_or_b64 s[72:73], s[72:73], s[74:75]
    s_cbranch_scc0 .K1_BIN_NOOVF
    s_movk_i32 s51, 1000
    v_lshrrev_b32 v35, 7, v35
    v_lshl_add_u32 v35, v35, 3, s51
    s_mov_b64 exec, s[62:63]
    ds_add_rtn_u32 v40, v35, v9
    s_mov_b64 exec, -1
    v_lshrrev_b32 v36, 7, v36
    v_lshl_add_u32 v36, v36, 3, s51
    s_mov_b64 exec, s[64:65]
    ds_add_rtn_u32 v41, v36, v9
    s_mov_b64 exec, -1
    v_lshrrev_b32 v37, 7, v37
    v_lshl_add_u32 v37, v37, 3, s51
    s_mov_b64 exec, s[66:67]
    ds_add_rtn_u32 v42, v37, v9
    s_mov_b64 exec, -1
    v_lshrrev_b32 v38, 7, v38
    v_lshl_add_u32 v38, v38, 3, s51
    s_mov_b64 exec, s[68:69]
    ds_add_rtn_u32 v43, v38, v9
    s_mov_b64 exec, -1
    v_lshrrev_b32 v39, 7, v39
    v_lshl_add_u32 v39, v39, 3, s51
    s_mov_b64 exec, s[70:71]
    ds_add_rtn_u32 v44, v39, v9
    s_mov_b64 exec, -1
    v_mov_b32 v57, -2
    s_waitcnt lgkmcnt(0)
    v_cmp_gt_u32 vcc, 31, v40
    v_min_u32 v55, 31, v40
    s_nop 0
    v_cndmask_b32 v50, v57, v50, vcc
    v_lshlrev_b32 v55, 2, v55
    v_lshl_add_u32 v55, v35, 4, v55
    v_lshlrev_b32 v56, 1, v55
    s_mov_b64 exec, s[62:63]
    ds_write_b32 v55, v50 offset:2048
    ds_write_b64 v56, v[20:21] offset:26624
    s_mov_b64 exec, -1
    v_cmp_gt_u32 vcc, 31, v41
    v_min_u32 v55, 31, v41
    s_nop 0
    v_cndmask_b32 v51, v57, v51, vcc
    v_lshlrev_b32 v55, 2, v55
    v_lshl_add_u32 v55, v36, 4, v55
    v_lshlrev_b32 v56, 1, v55
    s_mov_b64 exec, s[64:65]
    ds_write_b32 v55, v51 offset:2048
    ds_write_b64 v56, v[22:23] offset:26624
    s_mov_b64 exec, -1
    v_cmp_gt_u32 vcc, 31, v42
    v_min_u32 v55, 31, v42
    s_nop 0
    v_cndmask_b32 v52, v57, v52, vcc
    v_lshlrev_b32 v55, 2, v55
    v_lshl_add_u32 v55, v37, 4, v55
    v_lshlrev_b32 v56, 1, v55
    s_mov_b64 exec, s[66:67]
    ds_write_b32 v55, v52 offset:2048
    ds_write_b64 v56, v[24:25] offset:26624
    s_mov_b64 exec, -1
    v_cmp_gt_u32 vcc, 31, v43
    v_min_u32 v55, 31, v43
    s_nop 0
    v_cndmask_b32 v53, v57, v53, vcc
    v_lshlrev_b32 v55, 2, v55
    v_lshl_add_u32 v55, v38, 4, v55
    v_lshlrev_b32 v56, 1, v55
    s_mov_b64 exec, s[68:69]
    ds_write_b32 v55, v53 offset:2048
    ds_write_b64 v56, v[26:27] offset:26624
    s_mov_b64 exec, -1
    v_cmp_gt_u32 vcc, 31, v44
    v_min_u32 v55, 31, v44
    s_nop 0
    v_cndmask_b32 v54, v57, v54, vcc
    v_lshlrev_b32 v55, 2, v55
    v_lshl_add_u32 v55, v39, 4, v55
    v_lshlrev_b32 v56, 1, v55
    s_mov_b64 exec, s[70:71]
    ds_write_b32 v55, v54 offset:2048
    ds_write_b64 v56, v[28:29] offset:26624
    s_mov_b64 exec, -1
.K1_BIN_NOOVF:
    s_waitcnt lgkmcnt(0)
    s_barrier
    s_mov_b64 exec, s[86:87]
    ds_read_b128 v[34:37], v1 offset:59392
    ds_read_b128 v[38:41], v1 offset:18432
    s_mov_b64 exec, -1
    ds_read_b128 v[10:13], v1 offset:2048
    ds_read_b128 v[14:17], v1 offset:10240
    ds_read_b128 v[18:21], v1 offset:26624
    ds_read_b128 v[22:25], v1 offset:34816
    ds_read_b128 v[26:29], v1 offset:43008
    ds_read_b128 v[30:33], v1 offset:51200
    s_waitcnt lgkmcnt(5)
    buffer_store_dwordx4 v[10:13], v6, s[36:39], s76 offen sc1
    s_waitcnt lgkmcnt(4)
    buffer_store_dwordx4 v[14:17], v6, s[36:39], s77 offen sc1
    s_waitcnt lgkmcnt(3)
    buffer_store_dwordx4 v[18:21], v7, s[36:39], s78 offen sc1
    s_waitcnt lgkmcnt(2)
    buffer_store_dwordx4 v[22:25], v7, s[36:39], s79 offen sc1
    s_waitcnt lgkmcnt(1)
    buffer_store_dwordx4 v[26:29], v7, s[36:39], s80 offen sc1
    s_waitcnt lgkmcnt(0)
    buffer_store_dwordx4 v[30:33], v7, s[36:39], s81 offen sc1
    s_mov_b64 exec, s[86:87]
    buffer_store_dwordx4 v[34:37], v7, s[36:39], s82 offen sc1
    s_mov_b64 exec, s[84:85]
    buffer_store_dwordx4 v[38:41], v6, s[36:39], s83 offen sc1
    s_endpgm
.K1_GEMM:
    s_sub_u32 s3, s2, 64
    s_lshl_b32 s40, s3, 14
    v_lshrrev_b32 v1, 6, v0
    v_and_b32 v2, 63, v0
    v_readfirstlane_b32 s41, v1
    v_lshrrev_b32 v3, 4, v2
    v_and_b32 v4, 15, v2
    v_lshl_add_u32 v5, v1, 3, v3
    v_and_b32 v6, 15, v5
    v_xor_b32 v6, v6, v4
    v_lshlrev_b32 v6, 4, v6
    v_lshl_add_u32 v6, v5, 8, v6
    v_xor_b32 v7, 64, v6
    v_lshl_add_u32 v8, v1, 4, v3
    v_lshlrev_b32 v9, 1, v3
    v_xor_b32 v9, v9, v4
    v_lshlrev_b32 v9, 4, v9
    v_lshl_add_u32 v9, v8, 8, v9
    v_xor_b32 v10, 128, v9
    s_lshl_b32 s42, s41, 11
    s_lshl_b32 s43, s41, 12
    s_add_u32 s43, s43, 16384
    s_waitcnt lgkmcnt(0)
    s_mov_b32 s24, s4
    s_mov_b32 s25, s5
    s_mov_b32 s26, 2560000
    s_mov_b32 s27, 0x00020000
    s_mov_b32 s28, s14
    s_mov_b32 s29, s15
    s_mov_b32 s30, 66816
    s_mov_b32 s31, 0x00020000
    s_mov_b32 s32, s6
    s_mov_b32 s33, s7
    s_mov_b32 s34, 60000
    s_mov_b32 s35, 0x00020000
    s_mov_b32 s36, s20
    s_mov_b32 s37, s21
    s_mov_b32 s38, 11534336
    s_mov_b32 s39, 0x00020000
    s_mov_b32 s44, 32768
    s_lshl_b32 s45, s3, 6
    v_add_u32 v11, s45, v2
    v_lshlrev_b32 v124, 4, v11
    s_cmp_lg_u32 s41, 0
    s_cbranch_scc1 .K1_G_NOPOS
    v_mul_u32_u24 v12, 6, v11
    buffer_load_ushort v120, v12, s[32:35], 0 offen
    buffer_load_ushort v121, v12, s[32:35], 0 offen offset:2
    buffer_load_ushort v122, v12, s[32:35], 0 offen offset:4
    v_mov_b32 v123, 0
.K1_G_NOPOS:
    s_mov_b32 m0, s43
    s_nop 0
    buffer_load_dwordx4 v9, s[28:31], s44 offen offset:0 lds
    buffer_load_dwordx4 v9, s[28:31], s44 offen offset:1024 lds
    buffer_load_dwordx4 v10, s[28:31], s44 offen offset:2048 lds
    buffer_load_dwordx4 v10, s[28:31], s44 offen offset:3072 lds
    s_mov_b32 m0, s42
    s_nop 0
    buffer_load_dwordx4 v6, s[24:27], s40 offen lds
    buffer_load_dwordx4 v7, s[24:27], s40 offen offset:1024 lds
    s_add_u32 m0, s43, 32768
    s_nop 0
    buffer_load_dwordx4 v9, s[28:31], 0 offen offset:0 lds
    buffer_load_dwordx4 v9, s[28:31], 0 offen offset:1024 lds
    buffer_load_dwordx4 v10, s[28:31], 0 offen offset:2048 lds
    buffer_load_dwordx4 v10, s[28:31], 0 offen offset:3072 lds
    v_and_b32 v11, 3, v1
    v_lshrrev_b32 v12, 2, v1
    v_lshl_add_u32 v13, v11, 4, v4
    v_xor_b32 v14, v3, v4
    v_lshlrev_b32 v14, 4, v14
    v_lshl_add_u32 v14, v13, 8, v14
    v_xor_b32 v15, 64, v14
    v_xor_b32 v16, 128, v14
    v_xor_b32 v17, 192, v14
    v_lshrrev_b32 v18, 2, v4
    v_and_b32 v19, 1, v3
    v_lshl_or_b32 v19, v19, 2, v18
    v_lshlrev_b32 v20, 2, v12
    v_xor_b32 v19, v19, v20
    v_lshlrev_b32 v19, 5, v19
    v_and_b32 v20, 3, v4
    v_lshl_add_u32 v19, v20, 3, v19
    v_lshl_add_u32 v18, v3, 3, v18
    v_lshl_add_u32 v19, v18, 8, v19
    v_xor_b32 v20, 32, v19
    v_xor_b32 v21, 64, v19
    v_xor_b32 v22, 96, v19
    v_lshlrev_b32 v23, 2, v3
    v_lshl_add_u32 v23, v11, 4, v23
    v_lshlrev_b32 v23, 8, v23
    v_lshl_add_u32 v23, v12, 7, v23
    v_lshl_add_u32 v23, v4, 3, v23
    s_add_u32 s45, s40, 4096
    s_add_u32 s47, s40, 8388608
    s_mov_b32 s46, 3216550459
    s_mov_b32 s48, 2588672
    s_waitcnt vmcnt(4)
    s_barrier
    ds_read_b128 v[24:27], v14
    ds_read_b128 v[28:31], v15
    ds_read_b128 v[32:35], v16
    ds_read_b128 v[36:39], v17
    ds_read_b64_tr_b16 v[40:41], v19 offset:16384
    ds_read_b64_tr_b16 v[42:43], v19 offset:17408
    ds_read_b64_tr_b16 v[44:45], v20 offset:16384
    ds_read_b64_tr_b16 v[46:47], v20 offset:17408
    ds_read_b64_tr_b16 v[48:49], v21 offset:16384
    ds_read_b64_tr_b16 v[50:51], v21 offset:17408
    ds_read_b64_tr_b16 v[52:53], v22 offset:16384
    ds_read_b64_tr_b16 v[54:55], v22 offset:17408
    ds_read_b64_tr_b16 v[56:57], v19 offset:24576
    ds_read_b64_tr_b16 v[58:59], v19 offset:25600
    ds_read_b64_tr_b16 v[60:61], v20 offset:24576
    ds_read_b64_tr_b16 v[62:63], v20 offset:25600
    ds_read_b64_tr_b16 v[64:65], v21 offset:24576
    ds_read_b64_tr_b16 v[66:67], v21 offset:25600
    ds_read_b64_tr_b16 v[68:69], v22 offset:24576
    ds_read_b64_tr_b16 v[70:71], v22 offset:25600
    ds_read_b64_tr_b16 v[72:73], v19 offset:32768
    ds_read_b64_tr_b16 v[74:75], v19 offset:33792
    ds_read_b64_tr_b16 v[76:77], v20 offset:32768
    ds_read_b64_tr_b16 v[78:79], v20 offset:33792
    ds_read_b64_tr_b16 v[80:81], v21 offset:32768
    ds_read_b64_tr_b16 v[82:83], v21 offset:33792
    ds_read_b64_tr_b16 v[84:85], v22 offset:32768
    ds_read_b64_tr_b16 v[86:87], v22 offset:33792
    ds_read_b64_tr_b16 v[88:89], v19 offset:40960
    ds_read_b64_tr_b16 v[90:91], v19 offset:41984
    ds_read_b64_tr_b16 v[92:93], v20 offset:40960
    ds_read_b64_tr_b16 v[94:95], v20 offset:41984
    ds_read_b64_tr_b16 v[96:97], v21 offset:40960
    ds_read_b64_tr_b16 v[98:99], v21 offset:41984
    ds_read_b64_tr_b16 v[100:101], v22 offset:40960
    ds_read_b64_tr_b16 v[102:103], v22 offset:41984
    s_waitcnt lgkmcnt(15)
    v_mfma_f32_16x16x32_bf16 v[104:107], v[24:27], v[40:43], 0
    s_waitcnt lgkmcnt(15)
    v_mfma_f32_16x16x32_bf16 v[108:111], v[24:27], v[44:47], 0
    s_waitcnt lgkmcnt(15)
    v_mfma_f32_16x16x32_bf16 v[112:115], v[24:27], v[48:51], 0
    s_waitcnt lgkmcnt(15)
    v_mfma_f32_16x16x32_bf16 v[116:119], v[24:27], v[52:55], 0
    s_waitcnt lgkmcnt(15)
    v_mfma_f32_16x16x32_bf16 v[104:107], v[28:31], v[56:59], v[104:107]
    s_waitcnt lgkmcnt(15)
    v_mfma_f32_16x16x32_bf16 v[108:111], v[28:31], v[60:63], v[108:111]
    s_waitcnt lgkmcnt(15)
    v_mfma_f32_16x16x32_bf16 v[112:115], v[28:31], v[64:67], v[112:115]
    s_waitcnt lgkmcnt(15)
    v_mfma_f32_16x16x32_bf16 v[116:119], v[28:31], v[68:71], v[116:119]
    s_waitcnt lgkmcnt(14)
    v_mfma_f32_16x16x32_bf16 v[104:107], v[32:35], v[72:75], v[104:107]
    s_waitcnt lgkmcnt(12)
    v_mfma_f32_16x16x32_bf16 v[108:111], v[32:35], v[76:79], v[108:111]
    s_waitcnt lgkmcnt(10)
    v_mfma_f32_16x16x32_bf16 v[112:115], v[32:35], v[80:83], v[112:115]
    s_waitcnt lgkmcnt(8)
    v_mfma_f32_16x16x32_bf16 v[116:119], v[32:35], v[84:87], v[116:119]
    s_waitcnt lgkmcnt(6)
    v_mfma_f32_16x16x32_bf16 v[104:107], v[36:39], v[88:91], v[104:107]
    s_waitcnt lgkmcnt(4)
    v_mfma_f32_16x16x32_bf16 v[108:111], v[36:39], v[92:95], v[108:111]
    s_waitcnt lgkmcnt(2)
    v_mfma_f32_16x16x32_bf16 v[112:115], v[36:39], v[96:99], v[112:115]
    s_waitcnt lgkmcnt(0)
    v_mfma_f32_16x16x32_bf16 v[116:119], v[36:39], v[100:103], v[116:119]
    s_waitcnt vmcnt(0)
    s_barrier
    v_add_u32 v19, 32768, v19
    v_add_u32 v20, 32768, v20
    v_add_u32 v21, 32768, v21
    v_add_u32 v22, 32768, v22
    ds_read_b64_tr_b16 v[40:41], v19 offset:16384
    ds_read_b64_tr_b16 v[42:43], v19 offset:17408
    ds_read_b64_tr_b16 v[44:45], v20 offset:16384
    ds_read_b64_tr_b16 v[46:47], v20 offset:17408
    ds_read_b64_tr_b16 v[48:49], v21 offset:16384
    ds_read_b64_tr_b16 v[50:51], v21 offset:17408
    ds_read_b64_tr_b16 v[52:53], v22 offset:16384
    ds_read_b64_tr_b16 v[54:55], v22 offset:17408
    ds_read_b64_tr_b16 v[56:57], v19 offset:24576
    ds_read_b64_tr_b16 v[58:59], v19 offset:25600
    ds_read_b64_tr_b16 v[60:61], v20 offset:24576
    ds_read_b64_tr_b16 v[62:63], v20 offset:25600
    ds_read_b64_tr_b16 v[64:65], v21 offset:24576
    ds_read_b64_tr_b16 v[66:67], v21 offset:25600
    ds_read_b64_tr_b16 v[68:69], v22 offset:24576
    ds_read_b64_tr_b16 v[70:71], v22 offset:25600
    ds_read_b64_tr_b16 v[72:73], v19 offset:32768
    ds_read_b64_tr_b16 v[74:75], v19 offset:33792
    ds_read_b64_tr_b16 v[76:77], v20 offset:32768
    ds_read_b64_tr_b16 v[78:79], v20 offset:33792
    ds_read_b64_tr_b16 v[80:81], v21 offset:32768
    ds_read_b64_tr_b16 v[82:83], v21 offset:33792
    ds_read_b64_tr_b16 v[84:85], v22 offset:32768
    ds_read_b64_tr_b16 v[86:87], v22 offset:33792
    ds_read_b64_tr_b16 v[88:89], v19 offset:40960
    ds_read_b64_tr_b16 v[90:91], v19 offset:41984
    ds_read_b64_tr_b16 v[92:93], v20 offset:40960
    ds_read_b64_tr_b16 v[94:95], v20 offset:41984
    ds_read_b64_tr_b16 v[96:97], v21 offset:40960
    ds_read_b64_tr_b16 v[98:99], v21 offset:41984
    ds_read_b64_tr_b16 v[100:101], v22 offset:40960
    ds_read_b64_tr_b16 v[102:103], v22 offset:41984
    v_mul_f32 v104, s46, v104
    v_mul_f32 v105, s46, v105
    v_mul_f32 v106, s46, v106
    v_mul_f32 v107, s46, v107
    v_mul_f32 v108, s46, v108
    v_mul_f32 v109, s46, v109
    v_mul_f32 v110, s46, v110
    v_mul_f32 v111, s46, v111
    v_mul_f32 v112, s46, v112
    v_mul_f32 v113, s46, v113
    v_mul_f32 v114, s46, v114
    v_mul_f32 v115, s46, v115
    v_mul_f32 v116, s46, v116
    v_mul_f32 v117, s46, v117
    v_mul_f32 v118, s46, v118
    v_mul_f32 v119, s46, v119
    v_cvt_pk_bf16_f32 v128, v104, v108
    v_cvt_pk_bf16_f32 v129, v112, v116
    buffer_store_dwordx2 v[128:129], v23, s[36:39], s45 offen offset:0 sc1
    v_cvt_pk_bf16_f32 v130, v105, v109
    v_cvt_pk_bf16_f32 v131, v113, v117
    buffer_store_dwordx2 v[130:131], v23, s[36:39], s45 offen offset:256 sc1
    v_cvt_pk_bf16_f32 v132, v106, v110
    v_cvt_pk_bf16_f32 v133, v114, v118
    buffer_store_dwordx2 v[132:133], v23, s[36:39], s45 offen offset:512 sc1
    v_cvt_pk_bf16_f32 v134, v107, v111
    v_cvt_pk_bf16_f32 v135, v115, v119
    buffer_store_dwordx2 v[134:135], v23, s[36:39], s45 offen offset:768 sc1
    s_cmp_lg_u32 s41, 0
    s_cbranch_scc1 .K1_G_NOPOS2
    v_lshl_or_b32 v126, v120, 16, v122
    v_lshlrev_b32 v127, 16, v121
    v_lshrrev_b32 v125, 1, v124
    s_mov_b32 s49, 2883584
    buffer_store_dwordx2 v[126:127], v125, s[36:39], s49 offen sc1
    v_lshlrev_b32 v120, 16, v120
    v_lshlrev_b32 v121, 16, v121
    v_lshlrev_b32 v122, 16, v122
    buffer_store_dwordx4 v[120:123], v124, s[36:39], s48 offen sc1
.K1_G_NOPOS2:
    s_waitcnt lgkmcnt(15)
    v_mfma_f32_16x16x32_bf16 v[104:107], v[24:27], v[40:43], 0
    s_waitcnt lgkmcnt(15)
    v_mfma_f32_16x16x32_bf16 v[108:111], v[24:27], v[44:47], 0
    s_waitcnt lgkmcnt(15)
    v_mfma_f32_16x16x32_bf16 v[112:115], v[24:27], v[48:51], 0
    s_waitcnt lgkmcnt(15)
    v_mfma_f32_16x16x32_bf16 v[116:119], v[24:27], v[52:55], 0
    s_waitcnt lgkmcnt(15)
    v_mfma_f32_16x16x32_bf16 v[104:107], v[28:31], v[56:59], v[104:107]
    s_waitcnt lgkmcnt(15)
    v_mfma_f32_16x16x32_bf16 v[108:111], v[28:31], v[60:63], v[108:111]
    s_waitcnt lgkmcnt(15)
    v_mfma_f32_16x16x32_bf16 v[112:115], v[28:31], v[64:67], v[112:115]
    s_waitcnt lgkmcnt(15)
    v_mfma_f32_16x16x32_bf16 v[116:119], v[28:31], v[68:71], v[116:119]
    s_waitcnt lgkmcnt(14)
    v_mfma_f32_16x16x32_bf16 v[104:107], v[32:35], v[72:75], v[104:107]
    s_waitcnt lgkmcnt(12)
    v_mfma_f32_16x16x32_bf16 v[108:111], v[32:35], v[76:79], v[108:111]
    s_waitcnt lgkmcnt(10)
    v_mfma_f32_16x16x32_bf16 v[112:115], v[32:35], v[80:83], v[112:115]
    s_waitcnt lgkmcnt(8)
    v_mfma_f32_16x16x32_bf16 v[116:119], v[32:35], v[84:87], v[116:119]
    s_waitcnt lgkmcnt(6)
    v_mfma_f32_16x16x32_bf16 v[104:107], v[36:39], v[88:91], v[104:107]
    s_waitcnt lgkmcnt(4)
    v_mfma_f32_16x16x32_bf16 v[108:111], v[36:39], v[92:95], v[108:111]
    s_waitcnt lgkmcnt(2)
    v_mfma_f32_16x16x32_bf16 v[112:115], v[36:39], v[96:99], v[112:115]
    s_waitcnt lgkmcnt(0)
    v_mfma_f32_16x16x32_bf16 v[116:119], v[36:39], v[100:103], v[116:119]
    s_nop 1
    v_mul_f32 v104, s46, v104
    v_mul_f32 v105, s46, v105
    v_mul_f32 v106, s46, v106
    v_mul_f32 v107, s46, v107
    v_mul_f32 v108, s46, v108
    v_mul_f32 v109, s46, v109
    v_mul_f32 v110, s46, v110
    v_mul_f32 v111, s46, v111
    v_mul_f32 v112, s46, v112
    v_mul_f32 v113, s46, v113
    v_mul_f32 v114, s46, v114
    v_mul_f32 v115, s46, v115
    v_mul_f32 v116, s46, v116
    v_mul_f32 v117, s46, v117
    v_mul_f32 v118, s46, v118
    v_mul_f32 v119, s46, v119
    v_cvt_pk_bf16_f32 v136, v104, v108
    v_cvt_pk_bf16_f32 v137, v112, v116
    buffer_store_dwordx2 v[136:137], v23, s[36:39], s47 offen offset:0 sc1
    v_cvt_pk_bf16_f32 v138, v105, v109
    v_cvt_pk_bf16_f32 v139, v113, v117
    buffer_store_dwordx2 v[138:139], v23, s[36:39], s47 offen offset:256 sc1
    v_cvt_pk_bf16_f32 v140, v106, v110
    v_cvt_pk_bf16_f32 v141, v114, v118
    buffer_store_dwordx2 v[140:141], v23, s[36:39], s47 offen offset:512 sc1
    v_cvt_pk_bf16_f32 v142, v107, v111
    v_cvt_pk_bf16_f32 v143, v115, v119
    buffer_store_dwordx2 v[142:143], v23, s[36:39], s47 offen offset:768 sc1
    s_endpgm
.K1_WPREP:
    s_sub_u32 s3, s2, 221
    s_and_b32 s40, s3, 3
    s_lshr_b32 s41, s3, 2
    s_lshl_b32 s40, s40, 9
    v_add_u32 v1, s40, v0
    v_lshrrev_b32 v2, 8, v1
    v_bfe_u32 v3, v1, 6, 2
    v_bfe_u32 v4, v1, 4, 2
    v_and_b32 v5, 15, v1
    v_lshl_add_u32 v6, v2, 4, v5
    v_lshlrev_b32 v7, 2, v3
    v_add_u32 v7, v7, v4
    v_lshlrev_b32 v7, 11, v7
    v_lshlrev_b32 v16, 4, v1
    s_waitcnt lgkmcnt(0)
    s_mov_b32 s28, s14
    s_mov_b32 s29, s15
    s_mov_b32 s30, 66816
    s_mov_b32 s31, 0x00020000
    s_mov_b32 s32, s18
    s_mov_b32 s33, s19
    s_mov_b32 s34, 65536
    s_mov_b32 s35, 0x00020000
    s_mov_b32 s36, s20
    s_mov_b32 s37, s21
    s_mov_b32 s38, 11534336
    s_mov_b32 s39, 0x00020000
    s_cmp_eq_u32 s41, 1
    s_cbranch_scc1 .K1_WP2
    v_lshl_add_u32 v8, v6, 1, v7
    buffer_load_ushort v20, v8, s[32:35], 0 offen offset:0
    buffer_load_ushort v21, v8, s[32:35], 0 offen offset:256
    buffer_load_ushort v22, v8, s[32:35], 0 offen offset:512
    buffer_load_ushort v23, v8, s[32:35], 0 offen offset:768
    buffer_load_ushort v24, v8, s[32:35], 0 offen offset:1024
    buffer_load_ushort v25, v8, s[32:35], 0 offen offset:1280
    buffer_load_ushort v26, v8, s[32:35], 0 offen offset:1536
    buffer_load_ushort v27, v8, s[32:35], 0 offen offset:1792
    s_mov_b32 s42, 2785280
    s_waitcnt vmcnt(0)
    v_lshl_or_b32 v10, v21, 16, v20
    v_lshl_or_b32 v11, v23, 16, v22
    v_lshl_or_b32 v12, v25, 16, v24
    v_lshl_or_b32 v13, v27, 16, v26
    buffer_store_dwordx4 v[10:13], v16, s[36:39], s42 offen sc1
    s_endpgm
.K1_WP2:
    v_lshrrev_b32 v8, 1, v3
    v_lshlrev_b32 v8, 6, v8
    v_and_b32 v9, 1, v3
    v_lshl_add_u32 v8, v9, 3, v8
    v_and_b32 v9, 1, v4
    v_lshl_add_u32 v8, v9, 2, v8
    v_lshrrev_b32 v9, 1, v4
    v_add_u32 v8, v8, v9
    v_lshlrev_b32 v8, 8, v8
    v_lshl_add_u32 v8, v6, 1, v8
    s_mov_b32 s44, 32768
    s_mov_b32 s45, 36864
    s_mov_b32 s46, 40960
    s_mov_b32 s47, 45056
    s_mov_b32 s48, 32768
    s_mov_b32 s49, 36864
    s_mov_b32 s50, 40960
    s_mov_b32 s51, 45056
    buffer_load_ushort v20, v8, s[32:35], s44 offen offset:0
    buffer_load_ushort v21, v8, s[32:35], s45 offen offset:0
    buffer_load_ushort v22, v8, s[32:35], s46 offen offset:0
    buffer_load_ushort v23, v8, s[32:35], s47 offen offset:0
    buffer_load_ushort v24, v8, s[32:35], s48 offen offset:512
    buffer_load_ushort v25, v8, s[32:35], s49 offen offset:512
    buffer_load_ushort v26, v8, s[32:35], s50 offen offset:512
    buffer_load_ushort v27, v8, s[32:35], s51 offen offset:512
    s_mov_b32 s42, 2818048
    s_waitcnt vmcnt(0)
    v_lshl_or_b32 v10, v21, 16, v20
    v_lshl_or_b32 v11, v23, 16, v22
    v_lshl_or_b32 v12, v25, 16, v24
    v_lshl_or_b32 v13, v27, 16, v26
    buffer_store_dwordx4 v[10:13], v16, s[36:39], s42 offen sc1
    s_endpgm
.K1_WSM:
    v_lshrrev_b32 v1, 7, v0
    s_nop 0
    v_readfirstlane_b32 s3, v1
    v_and_b32 v6, 127, v0
    s_waitcnt lgkmcnt(0)
    s_mov_b32 s28, s14
    s_mov_b32 s29, s15
    s_mov_b32 s30, 66816
    s_mov_b32 s31, 0x00020000
    s_mov_b32 s32, s16
    s_mov_b32 s33, s17
    s_mov_b32 s34, 256
    s_mov_b32 s35, 0x00020000
    s_mov_b32 s36, s20
    s_mov_b32 s37, s21
    s_mov_b32 s38, 11534336
    s_mov_b32 s39, 0x00020000
    s_cmp_eq_u32 s3, 1
    s_cbranch_scc1 .K1_WXK
    s_cmp_lg_u32 s3, 0
    s_cbranch_scc1 .K1_END
    v_and_b32 v8, 64, v6
    v_and_b32 v9, 3, v6
    v_lshl_add_u32 v8, v9, 4, v8
    v_bfe_u32 v9, v6, 2, 4
    v_add_u32 v8, v8, v9
    v_lshlrev_b32 v8, 1, v8
    s_mov_b32 s40, 65536
    buffer_load_ushort v10, v8, s[28:31], s40 offen offset:0
    buffer_load_ushort v11, v8, s[28:31], s40 offen offset:256
    buffer_load_ushort v12, v8, s[28:31], s40 offen offset:512
    buffer_load_ushort v13, v8, s[28:31], s40 offen offset:768
    buffer_load_ushort v14, v8, s[28:31], s40 offen offset:1024
    s_mov_b32 s41, 3216550459
    s_mov_b32 s42, 2850816
    v_lshlrev_b32 v16, 1, v6
    s_waitcnt vmcnt(0)
    v_lshlrev_b32 v10, 16, v10
    v_mul_f32 v10, s41, v10
    v_lshlrev_b32 v11, 16, v11
    v_mul_f32 v11, s41, v11
    v_lshlrev_b32 v12, 16, v12
    v_mul_f32 v12, s41, v12
    v_lshlrev_b32 v13, 16, v13
    v_mul_f32 v13, s41, v13
    v_lshlrev_b32 v14, 16, v14
    v_mul_f32 v14, s41, v14
    v_cvt_pk_bf16_f32 v20, v11, v12
    v_cvt_pk_bf16_f32 v21, v13, v14
    v_cvt_pk_bf16_f32 v22, v10, v10
    v_lshlrev_b32 v17, 16, v22
    v_sub_f32 v17, v10, v17
    v_cvt_pk_bf16_f32 v22, v10, v17
    v_mov_b32 v23, 0
    buffer_store_short v20, v16, s[36:39], s42 offen offset:0 sc1
    buffer_store_short_d16_hi v20, v16, s[36:39], s42 offen offset:256 sc1
    buffer_store_short v21, v16, s[36:39], s42 offen offset:512 sc1
    buffer_store_short_d16_hi v21, v16, s[36:39], s42 offen offset:768 sc1
    buffer_store_short v22, v16, s[36:39], s42 offen offset:1024 sc1
    buffer_store_short_d16_hi v22, v16, s[36:39], s42 offen offset:1280 sc1
    buffer_store_short v23, v16, s[36:39], s42 offen offset:1536 sc1
    buffer_store_short_d16_hi v23, v16, s[36:39], s42 offen offset:1792 sc1
    s_endpgm
.K1_WXK:
    v_and_b32 v8, 64, v6
    v_and_b32 v9, 3, v6
    v_lshl_add_u32 v8, v9, 4, v8
    v_bfe_u32 v9, v6, 5, 1
    v_lshl_add_u32 v8, v9, 3, v8
    v_bfe_u32 v9, v6, 2, 2
    v_lshl_add_u32 v8, v9, 1, v8
    v_bfe_u32 v9, v6, 4, 1
    v_add_u32 v8, v8, v9
    v_lshlrev_b32 v8, 1, v8
    buffer_load_ushort v10, v8, s[32:35], 0 offen
    s_mov_b32 s42, 2852864
    v_lshlrev_b32 v16, 1, v6
    s_waitcnt vmcnt(0)
    buffer_store_short v10, v16, s[36:39], s42 offen sc1
.K1_END:
    s_endpgm
.globl egnn_main_kernel
.p2align 8
.type egnn_main_kernel,@function
egnn_main_kernel:
    s_load_dwordx16 s[4:19], s[0:1], 0
    s_load_dwordx2 s[20:21], s[0:1], 64
    s_load_dwordx2 s[22:23], s[0:1], 80
    s_cmp_lt_u32 s2, 250
    s_cbranch_scc1 .K2_GO
    s_endpgm
.K2_GO:
    v_lshlrev_b32 v160, 3, v0
    v_lshrrev_b32 v165, 6, v0
    v_lshlrev_b32 v161, 4, v0
    v_readfirstlane_b32 s56, v165
    v_and_b32 v221, 63, v0
    s_lshl_b32 s70, s2, 12
    s_add_u32 s70, s70, 3145728
    s_lshr_b32 s71, s2, 5
    s_lshl_b32 s90, s71, 14
    s_add_u32 s90, s90, 6307840
    s_lshl_b32 s71, s71, 13
    s_add_u32 s71, s71, 4169728
    s_add_u32 s96, s71, 4096
    s_lshl_b32 s72, s2, 13
    s_add_u32 s72, s72, 4259840
    v_mov_b32 v166, 1073741824
    v_mov_b32 v167, 1073741824
    v_and_b32 v168, 248, v160
    v_mov_b32 v169, 0
    ds_write_b64 v160, v[166:167] offset:256
    ds_write2_b32 v168, v169, v169 offset0:0 offset1:1
    v_lshrrev_b32 v163, 4, v221
    v_and_b32 v164, 15, v221
    v_lshlrev_b32 v162, 4, v221
    s_and_b32 s73, s56, 3
    s_lshl_b32 s73, s73, 2
    v_add_u32 v165, s73, v163
    v_xor_b32 v165, v165, v164
    v_lshlrev_b32 v165, 4, v165
    v_lshl_add_u32 v165, v163, 8, v165
    s_lshl_b32 s74, s56, 10
    s_mul_i32 s79, s2, 10240
    s_add_u32 s73, s79, s74
    s_add_u32 s75, s73, 8388608
    s_mul_i32 s89, s2, 640
    s_add_u32 s89, s89, 2588672
    s_add_u32 s76, s75, 6144
    s_add_u32 s77, s74, 2846720
    s_cmp_lt_u32 s56, 4
    s_cselect_b32 s76, s76, s77
    s_add_u32 s77, s74, 155520
    s_cmp_eq_u32 s56, 7
    s_cselect_b32 s76, s89, s76
    s_cselect_b32 s77, 4352, s77
    s_waitcnt lgkmcnt(0)
    s_mov_b32 s24, s22
    s_mov_b32 s25, s23
    s_mov_b32 s26, 11534336
    s_mov_b32 s27, 0x00020000
    buffer_load_dwordx2 v[154:155], v160, s[24:27], s70 offen
    buffer_load_dwordx2 v[58:59], v160, s[24:27], s71 offen
    s_barrier
    s_mov_b32 s28, s4
    s_mov_b32 s29, s5
    s_mov_b32 s30, 2560000
    s_mov_b32 s31, 0x00020000
    s_add_u32 m0, s74, 149376
    s_nop 0
    buffer_load_dwordx4 v162, s[24:27], s75 offen lds
    s_cmp_gt_u32 s56, 1
    s_cbranch_scc1 .K2_DW
    s_add_u32 m0, s74, 146688
    s_add_u32 s77, s73, 8192
    buffer_load_dwordx4 v165, s[28:31], s77 offen lds
    s_branch .K2_DD
.K2_DW:
    s_mov_b32 m0, s77
    s_nop 0
    buffer_load_dwordx4 v162, s[24:27], s76 offen lds
.K2_DD:
    s_add_u32 m0, s74, 138496
    s_nop 0
    buffer_load_dwordx4 v165, s[28:31], s73 offen lds
    v_lshlrev_b32 v170, 1, v160
    v_mov_b32 v166, 0
    v_mov_b32 v167, 0
    v_mov_b32 v168, 0
    v_mov_b32 v169, 0
    ds_write_b128 v170, v[166:169] offset:5376
    ds_write_b128 v170, v[166:169] offset:13568
    ds_write_b128 v170, v[166:169] offset:21760
    ds_write_b128 v170, v[166:169] offset:29952
    ds_write_b128 v170, v[166:169] offset:38144
    ds_write_b128 v170, v[166:169] offset:46336
    ds_write_b128 v170, v[166:169] offset:54528
    ds_write_b128 v170, v[166:169] offset:62720
    buffer_load_dwordx4 v[128:131], v161, s[24:27], s72 offen
    s_mov_b32 s32, s22
    s_mov_b32 s33, s23
    s_mov_b32 s34, 2564096
    s_mov_b32 s35, 0x00020000
    s_mov_b32 s58, s56
    v_lshrrev_b32 v166, 3, v221
    s_lshl_b32 s70, s58, 9
    s_add_u32 s70, s70, 256
    v_lshl_add_u32 v218, v166, 4, s70
    s_mul_i32 s68, s56, 8448
    s_add_u32 s68, s68, 70912
    s_add_u32 s57, s68, 4224
    v_and_b32 v220, 7, v221
    v_lshlrev_b32 v220, 4, v220
    s_movk_i32 s64, 4096
    s_movk_i32 s65, 3040
    s_movk_i32 s66, 1984
    s_movk_i32 s67, 928
    s_movk_i32 s14, 4224
    s_movk_i32 s15, 3168
    s_movk_i32 s16, 2112
    s_movk_i32 s17, 1056
    s_mov_b32 s88, 2588672
    s_mov_b32 s61, 0
    s_movk_i32 s91, 128
    v_mov_b32 v185, 0x3f80
    v_mov_b32 v186, 1
    v_mov_b32 v174, 0
    v_lshrrev_b32 v176, 2, v220
    v_lshlrev_b32 v180, 2, v221
    v_cmp_lt_u32 vcc, 0, v176
    v_cmp_lt_u32 s[70:71], 4, v176
    v_cmp_lt_u32 s[72:73], 12, v176
    v_cndmask_b32 v177, 0, -1, vcc
    v_cndmask_b32 v178, 0, -1, s[70:71]
    v_cndmask_b32 v179, 0, -1, s[72:73]
    v_lshrrev_b32 v181, 3, v221
    v_or_b32 v182, 28, v180
    v_lshl_add_u32 v183, v220, 1, 28
    v_sub_u32 v181, 7, v181
    s_sub_u32 s59, 11, s56
    s_cmp_lt_u32 s56, 4
    s_cselect_b32 s59, s56, s59
    s_mov_b32 s78, 0x80808080
    s_mov_b32 s79, 0x80808080
    v_lshlrev_b32 v167, 8, v164
    v_lshl_add_u32 v222, v163, 3, v167
    s_lshl_b32 s6, s56, 12
    s_add_u32 s6, s6, 2785280
    s_add_u32 s7, s6, 32768
    s_mov_b32 s58, 0
    v_bfe_u32 v16, v221, 4, 1
    v_and_b32 v17, 3, v221
    v_lshlrev_b32 v16, 5, v16
    v_lshl_add_u32 v16, v17, 3, v16
    v_bfe_u32 v17, v221, 2, 2
    v_lshrrev_b32 v18, 5, v221
    v_lshl_add_u32 v18, v18, 2, v17
    v_lshl_add_u32 v16, v17, 8, v16
    s_mul_i32 s72, s58, 1280
    s_add_u32 s73, s72, 149888
    s_add_u32 s72, s72, 148864
    v_mov_b32 v223, 161152
    v_cmp_gt_u32 vcc, 4, v18
    v_cmp_eq_u32 s[70:71], 7, v18
    v_mov_b32 v19, 159616
    v_mov_b32 v20, 160640
    v_mov_b32 v17, s73
    v_cndmask_b32 v172, v17, v19, vcc
    v_cndmask_b32 v172, v172, v20, s[70:71]
    v_cmp_gt_u32 s[70:71], 2, v18
    v_mov_b32 v17, s72
    v_add_u32 v172, v172, v16
    v_cndmask_b32 v173, v17, v20, s[70:71]
    v_add_u32 v173, v173, v16
    v_cndmask_b32 v173, v223, v173, vcc
    v_mov_b32 v16, 1280
    v_cmp_eq_u32 s[70:71], 7, v18
    v_cmp_gt_u32 s[72:73], 2, v18
    v_cndmask_b32 v175, v16, 0, vcc
    v_cndmask_b32 v187, 0, v16, vcc
    v_cndmask_b32 v175, v175, 0, s[70:71]
    v_cndmask_b32 v187, v187, 0, s[72:73]
    v_and_b32 v16, 31, v221
    v_and_b32 v17, 1, v221
    v_lshlrev_b32 v17, 4, v17
    v_lshrrev_b32 v18, 5, v221
    v_lshlrev_b32 v17, v17, v185
    v_lshlrev_b32 v18, 3, v18
    v_sub_u32 v16, v16, v18
    v_lshrrev_b32 v16, 1, v16
    v_cmp_eq_u32 vcc, 0, v16
    v_cmp_eq_u32 s[70:71], 8, v16
    v_mov_b32 v196, 0x3e803e80
    v_cndmask_b32 v188, 0, v17, vcc
    v_cndmask_b32 v192, 0, v17, s[70:71]
    v_cmp_eq_u32 vcc, 1, v16
    v_cmp_eq_u32 s[70:71], 9, v16
    v_mov_b32 v197, 0x3e803e80
    v_cndmask_b32 v189, 0, v17, vcc
    v_cndmask_b32 v193, 0, v17, s[70:71]
    v_cmp_eq_u32 vcc, 2, v16
    v_cmp_eq_u32 s[70:71], 10, v16
    v_mov_b32 v198, 0x3e803e80
    v_cndmask_b32 v190, 0, v17, vcc
    v_cndmask_b32 v194, 0, v17, s[70:71]
    v_cmp_eq_u32 vcc, 3, v16
    v_cmp_eq_u32 s[70:71], 11, v16
    v_mov_b32 v199, 0x3e803e80
    v_cndmask_b32 v191, 0, v17, vcc
    v_cndmask_b32 v195, 0, v17, s[70:71]
    s_mov_b32 s58, s56
    v_mov_b32 v112, 0
    v_mov_b32 v113, 0
    v_mov_b32 v114, 0
    v_mov_b32 v115, 0
    s_mov_b32 s98, 2883584
    s_waitcnt vmcnt(4)
    v_cmp_ne_u32 s[80:81], -1, v154
    v_cmp_ne_u32 s[82:83], -1, v155
    v_and_b32 v139, 0x3fff00, v154
    v_lshrrev_b32 v168, 5, v139
    v_and_b32 v152, 0x3fff00, v155
    v_lshrrev_b32 v169, 5, v152
    s_or_b32 exec_lo, s80, 1
    s_mov_b32 exec_hi, s81
    buffer_load_dwordx2 v[136:137], v168, s[24:27], s98 offen
    s_or_b32 exec_lo, s82, 1
    s_mov_b32 exec_hi, s83
    buffer_load_dwordx2 v[144:145], v169, s[24:27], s98 offen
    s_mov_b64 exec, -1
    v_lshrrev_b32 v166, 22, v58
    v_lshrrev_b32 v167, 22, v59
    v_and_b32 v134, 0x1c, v154
    v_lshl_or_b32 v141, v134, 3, v176
    s_mov_b64 exec, s[80:81]
    ds_add_rtn_u32 v133, v141, v186 offset:0
    s_mov_b64 exec, -1
    v_and_b32 v147, 0x1c, v155
    v_lshl_or_b32 v149, v147, 3, v176
    s_mov_b64 exec, s[82:83]
    ds_add_rtn_u32 v143, v149, v186 offset:0
    s_mov_b64 exec, -1
    v_cmp_ne_u32 vcc, -1, v59
    v_cmp_eq_u32 s[84:85], s2, v166
    v_cmp_eq_u32 s[86:87], s2, v167
    v_bfe_u32 v135, v154, 5, 3
    v_mul_u32_u24 v140, 20, v134
    v_lshl_add_u32 v140, v135, 4, v140
    v_bfe_u32 v151, v155, 5, 3
    v_mul_u32_u24 v148, 20, v147
    v_lshl_add_u32 v148, v151, 4, v148
    s_and_b64 vcc, vcc, s[78:79]
    s_or_b64 s[70:71], s[84:85], s[86:87]
    s_or_b64 s[70:71], s[70:71], vcc
    s_cbranch_scc0 .K2_NOB
    s_cbranch_vccz .K2_NOC
    buffer_load_dwordx2 v[60:61], v160, s[24:27], s96 offen
    v_mov_b32 v168, 0x10000
    s_waitcnt vmcnt(0)
    v_lshrrev_b32 v166, 22, v60
    v_lshrrev_b32 v167, 22, v61
    v_cmp_eq_u32 vcc, -2, v61
    v_cmp_eq_u32 s[70:71], s2, v166
    v_cmp_eq_u32 s[72:73], s2, v167
    s_or_b64 vcc, vcc, s[70:71]
    s_or_b64 exec, vcc, s[72:73]
    ds_add_u32 v174, v168 offset:0
    s_mov_b64 exec, -1
.K2_NOC:
    v_and_b32 v38, 0x1c, v58
    v_lshl_or_b32 v45, v38, 3, v176
    s_mov_b64 exec, s[84:85]
    ds_add_rtn_u32 v37, v45, v186 offset:0
    s_mov_b64 exec, -1
    v_and_b32 v51, 0x1c, v59
    v_lshl_or_b32 v53, v51, 3, v176
    s_mov_b64 exec, s[86:87]
    ds_add_rtn_u32 v47, v53, v186 offset:0
    s_mov_b64 exec, -1
    s_or_b64 s[70:71], s[84:85], s[86:87]
    s_or_b32 s70, s70, 1
    s_mov_b32 s61, 1
    s_mov_b64 exec, s[70:71]
    s_mov_b64 s[98:99], s[70:71]
    v_and_b32 v43, 0x3fff00, v58
    v_bfe_u32 v39, v58, 5, 3
    v_mul_u32_u24 v44, 20, v38
    v_lshrrev_b32 v58, 4, v43
    v_lshl_add_u32 v44, v39, 4, v44
    v_and_b32 v56, 0x3fff00, v59
    v_bfe_u32 v55, v59, 5, 3
    v_mul_u32_u24 v52, 20, v51
    v_lshrrev_b32 v59, 4, v56
    v_lshl_add_u32 v52, v55, 4, v52
    s_mov_b64 exec, -1
.K2_NOB:
    s_waitcnt lgkmcnt(0)
    s_barrier
    ds_read_b32 v166, v180 offset:0
    s_or_b64 s[78:79], s[84:85], s[86:87]
    s_waitcnt lgkmcnt(0)
    v_and_b32_dpp v168, v166, v177 row_shr:1 row_mask:0xf bank_mask:0xf bound_ctrl:0
    v_add_u32 v167, v166, v168
    s_nop 1
    v_and_b32_dpp v168, v167, v178 row_shr:2 row_mask:0xf bank_mask:0xf bound_ctrl:0
    v_add_u32 v167, v167, v168
    s_nop 1
    v_and_b32_dpp v168, v167, v179 row_shr:4 row_mask:0xf bank_mask:0xf bound_ctrl:0
    v_add_u32 v167, v167, v168
    v_sub_u32 v166, v167, v166
    v_cmp_lt_u32 vcc, s91, v167
    v_lshl_add_u32 v184, v167, 3, v181
    ds_bpermute_b32 v141, v141, v166
    ds_bpermute_b32 v149, v149, v166
    ds_bpermute_b32 v182, v182, v184
    ds_bpermute_b32 v183, v183, v184
    s_cbranch_scc0 .K2_NOB2
    ds_bpermute_b32 v45, v45, v166
    ds_bpermute_b32 v53, v53, v166
    s_mov_b64 s[70:71], vcc
    s_waitcnt lgkmcnt(0)
    v_add_u32 v37, v37, v45
    v_cmp_gt_u32 vcc, s91, v37
    v_lshl_add_u32 v38, v38, 5, v37
    v_lshlrev_b32 v169, 2, v38
    s_and_b64 s[84:85], vcc, s[84:85]
    s_mov_b64 exec, s[84:85]
    ds_write_b32 v169, v43 offset:256
    s_mov_b64 exec, -1
    v_add_u32 v47, v47, v53
    v_cmp_gt_u32 vcc, s91, v47
    v_lshl_add_u32 v51, v51, 5, v47
    v_lshlrev_b32 v170, 2, v51
    s_and_b64 s[86:87], vcc, s[86:87]
    s_mov_b64 exec, s[86:87]
    ds_write_b32 v170, v56 offset:256
    s_mov_b64 exec, -1
    s_mov_b64 vcc, s[70:71]
.K2_NOB2:
    s_cmp_lg_u64 vcc, 0
    s_cselect_b32 s62, 1, 0
    s_waitcnt lgkmcnt(0)
    v_add_u32 v133, v133, v141
    v_cmp_gt_u32 vcc, s91, v133
    v_lshl_add_u32 v134, v134, 5, v133
    v_lshlrev_b32 v169, 2, v134
    s_and_b64 s[80:81], vcc, s[80:81]
    s_mov_b64 exec, s[80:81]
    ds_write_b32 v169, v139 offset:256
    s_mov_b64 exec, -1
    v_add_u32 v143, v143, v149
    v_cmp_gt_u32 vcc, s91, v143
    v_lshl_add_u32 v147, v147, 5, v143
    v_lshlrev_b32 v170, 2, v147
    s_and_b64 s[82:83], vcc, s[82:83]
    s_mov_b64 exec, s[82:83]
    ds_write_b32 v170, v152 offset:256
    s_mov_b64 exec, -1
    v_cmp_gt_u32 vcc, v183, v182
    s_nop 1
    v_cndmask_b32 v182, 0, 1, vcc
    v_lshrrev_b32 v184, 3, v221
    s_nop 0
    v_add_u32_dpp v182, v182, v182 quad_perm:[1,0,3,2] row_mask:0xf bank_mask:0xf
    s_nop 1
    v_add_u32_dpp v182, v182, v182 quad_perm:[2,3,0,1] row_mask:0xf bank_mask:0xf
    s_nop 1
    v_add_u32_dpp v182, v182, v182 row_half_mirror row_mask:0xf bank_mask:0xf
    v_cmp_eq_u32 vcc, s59, v182
    s_ff1_i32_b64 s70, vcc
    s_lshr_b32 s58, s70, 3
    s_add_u32 s70, s70, 7
    v_readlane_b32 s59, v167, s70
    s_lshl_b32 s70, s58, 9
    s_add_u32 s70, s70, 256
    v_lshl_add_u32 v218, v184, 4, s70
    s_lshl_b32 s70, s58, 13
    v_mad_u32_u24 v172, v175, s58, v172
    v_mad_u32_u24 v173, v187, s58, v173
    s_min_u32 s59, s59, 128
    s_cmp_eq_u32 s61, 0
    s_cbranch_scc1 .K2_W0
    s_mov_b64 exec, s[98:99]
    buffer_load_dwordx4 v[32:35], v161, s[24:27], s90 offen
    buffer_load_dwordx3 v[40:42], v58, s[24:27], s88 offen
    buffer_load_dwordx3 v[48:50], v59, s[24:27], s88 offen
    s_mov_b64 exec, -1
.K2_W0:
    s_waitcnt vmcnt(6) lgkmcnt(0)
    s_cbranch_scc0 .K2_W1
    s_waitcnt vmcnt(3)
.K2_W1:
    s_barrier
    ds_read_b128 v[224:227], v218
    ds_read_b96 v[148:150], v148 offset:4352
    ds_read_b96 v[140:142], v140 offset:4352
    v_and_b32 v152, 12, v147
    v_lshlrev_b32 v147, 6, v147
    v_lshl_add_u32 v143, v151, 1, 12
    v_lshl_or_b32 v147, v152, 2, v147
    v_lshl_add_u32 v151, v151, 3, 24
    v_xor_b32 v143, v143, v147
    v_xor_b32 v151, v151, v147
    s_waitcnt lgkmcnt(2)
    v_add_u32 v224, v224, v220
    v_add_u32 v225, v225, v220
    v_add_u32 v226, v226, v220
    v_add_u32 v227, v227, v220
    s_mov_b32 m0, s68
    s_nop 0
    buffer_load_dwordx4 v224, s[32:35], s64 offen offset:0 lds
    buffer_load_dwordx4 v225, s[32:35], s65 offen offset:1056 lds
    buffer_load_dwordx4 v226, s[32:35], s66 offen offset:2112 lds
    buffer_load_dwordx4 v227, s[32:35], s67 offen offset:3168 lds
    v_and_b32 v139, 12, v134
    v_lshlrev_b32 v134, 6, v134
    v_lshl_add_u32 v133, v135, 1, 12
    v_lshl_or_b32 v134, v139, 2, v134
    v_lshl_add_u32 v135, v135, 3, 24
    v_xor_b32 v133, v133, v134
    v_xor_b32 v135, v135, v134
    s_or_b64 s[70:71], s[84:85], s[86:87]
    s_cbranch_scc0 .K2_NOPD
    s_mov_b64 exec, s[70:71]
    ds_read_b96 v[52:54], v52 offset:4352
    ds_read_b96 v[44:46], v44 offset:4352
    s_mov_b64 exec, -1
    v_and_b32 v56, 12, v51
    v_lshlrev_b32 v51, 6, v51
    v_lshl_add_u32 v47, v55, 1, 12
    v_lshl_or_b32 v51, v56, 2, v51
    v_lshl_add_u32 v55, v55, 3, 24
    v_xor_b32 v47, v47, v51
    v_xor_b32 v55, v55, v51
    v_and_b32 v43, 12, v38
    v_lshlrev_b32 v38, 6, v38
    v_lshl_add_u32 v37, v39, 1, 12
    v_lshl_or_b32 v38, v43, 2, v38
    v_lshl_add_u32 v39, v39, 3, 24
    v_xor_b32 v37, v37, v38
    v_xor_b32 v39, v39, v38
.K2_NOPD:
    v_and_b32 v16, 3, v221
    v_bfe_u32 v17, v221, 2, 3
    v_lshrrev_b32 v18, 5, v221
    v_mul_u32_u24 v219, 1056, v16
    v_lshl_add_u32 v219, v17, 7, v219
    v_lshl_add_u32 v17, v18, 4, s68
    v_add_u32 v219, v219, v17
    v_and_b32 v16, 31, v221
    v_lshrrev_b32 v19, 5, v221
    v_bfe_u32 v20, v221, 2, 2
    v_lshlrev_b32 v16, 6, v16
    v_xor_b32 v17, v20, v19
    v_lshl_add_u32 v16, v17, 4, v16
    v_lshl_add_u32 v17, v19, 2, v20
    v_lshlrev_b32 v17, 6, v17
    v_and_b32 v18, 3, v221
    v_bfe_u32 v20, v221, 4, 1
    v_lshl_or_b32 v18, v20, 2, v18
    v_min_u32 v18, 4, v18
    v_lshl_add_u32 v18, v18, 3, 24
    v_lshlrev_b32 v19, 4, v19
    v_xor_b32 v18, v18, v19
    v_add_u32 v17, v17, v18
    v_lshrrev_b32 v18, 3, v221
    v_lshlrev_b32 v18, 4, v18
    s_lshl_b32 s70, s58, 13
    s_add_u32 s70, s70, 5376
    v_add_u32 v216, s70, v16
    v_add_u32 v217, s70, v17
    s_cmp_lg_u32 s62, 0
    s_waitcnt vmcnt(4) lgkmcnt(0)
    s_cbranch_scc1 .K2_NOBUILD
    v_lshlrev_b32 v146, 16, v144
    v_and_b32 v144, 0xffff0000, v144
    v_sub_f32 v144, v148, v144
    v_sub_f32 v145, v149, v145
    v_sub_f32 v146, v150, v146
    v_cvt_pk_bf16_f32 v148, 1.0, v144
    v_cvt_pk_bf16_f32 v149, v145, v146
    v_dot2_f32_bf16 v144, v148, v148, -1.0
    s_mov_b64 exec, s[82:83]
    ds_write_b16 v143, v185 offset:5376
    ds_write_b64 v151, v[148:149] offset:5376
    v_dot2_f32_bf16 v144, v149, v149, v144
    s_nop 2
    v_cvt_pk_bf16_f32 v132, v144, v144
    ds_write_b96 v147, v[130:132] offset:5376
    s_mov_b64 exec, -1
    v_lshlrev_b32 v138, 16, v136
    v_and_b32 v136, 0xffff0000, v136
    v_sub_f32 v136, v140, v136
    v_sub_f32 v137, v141, v137
    v_sub_f32 v138, v142, v138
    v_cvt_pk_bf16_f32 v140, 1.0, v136
    v_cvt_pk_bf16_f32 v141, v137, v138
    v_dot2_f32_bf16 v136, v140, v140, -1.0
    s_mov_b64 exec, s[80:81]
    ds_write_b16 v133, v185 offset:5376
    ds_write_b64 v135, v[140:141] offset:5376
    v_dot2_f32_bf16 v136, v141, v141, v136
    s_nop 2
    v_cvt_pk_bf16_f32 v130, v136, v136
    ds_write_b96 v134, v[128:130] offset:5376
    s_mov_b64 exec, -1
    s_or_b64 s[70:71], s[84:85], s[86:87]
    s_cbranch_scc0 .K2_NOBUILD
    v_sub_f32 v48, v52, v48
    v_sub_f32 v49, v53, v49
    v_sub_f32 v50, v54, v50
    v_cvt_pk_bf16_f32 v52, 1.0, v48
    v_cvt_pk_bf16_f32 v53, v49, v50
    v_dot2_f32_bf16 v48, v52, v52, -1.0
    s_mov_b64 exec, s[86:87]
    ds_write_b16 v47, v185 offset:5376
    ds_write_b64 v55, v[52:53] offset:5376
    v_dot2_f32_bf16 v48, v53, v53, v48
    s_nop 2
    v_cvt_pk_bf16_f32 v36, v48, v48
    ds_write_b96 v51, v[34:36] offset:5376
    s_mov_b64 exec, -1
    v_sub_f32 v40, v44, v40
    v_sub_f32 v41, v45, v41
    v_sub_f32 v42, v46, v42
    v_cvt_pk_bf16_f32 v44, 1.0, v40
    v_cvt_pk_bf16_f32 v45, v41, v42
    v_dot2_f32_bf16 v40, v44, v44, -1.0
    s_mov_b64 exec, s[84:85]
    ds_write_b16 v37, v185 offset:5376
    ds_write_b64 v39, v[44:45] offset:5376
    v_dot2_f32_bf16 v40, v45, v45, v40
    s_nop 2
    v_cvt_pk_bf16_f32 v34, v40, v40
    ds_write_b96 v38, v[32:34] offset:5376
    s_mov_b64 exec, -1
.K2_NOBUILD:
    s_nop 1
    v_mfma_f32_32x32x16_bf16 v[0:15], v[112:115], v[196:199], 0
    v_mfma_f32_32x32x16_bf16 v[16:31], v[112:115], v[196:199], 0
    v_mfma_f32_32x32x16_bf16 v[32:47], v[112:115], v[196:199], 0
    v_mfma_f32_32x32x16_bf16 v[48:63], v[112:115], v[196:199], 0
    s_waitcnt lgkmcnt(0)
    s_barrier
    ds_read_b64_tr_b16 v[200:201], v172 offset:0
    ds_read_b64_tr_b16 v[202:203], v173 offset:0
    ds_read_b64_tr_b16 v[204:205], v172 offset:64
    ds_read_b64_tr_b16 v[206:207], v173 offset:64
    ds_read_b64_tr_b16 v[208:209], v172 offset:128
    ds_read_b64_tr_b16 v[210:211], v173 offset:128
    ds_read_b64_tr_b16 v[212:213], v172 offset:192
    ds_read_b64_tr_b16 v[214:215], v173 offset:192
    v_xor_b32 v229, 32, v217
    ds_read_b64_tr_b16 v[164:165], v217 offset:0
    ds_read_b64_tr_b16 v[168:169], v217 offset:1024
    ds_read_b64_tr_b16 v[166:167], v229 offset:512
    ds_read_b64_tr_b16 v[170:171], v229 offset:1536
    s_mov_b32 m0, s57
    s_nop 0
    buffer_load_dwordx4 v224, s[32:35], s14 offen offset:0 lds
    buffer_load_dwordx4 v225, s[32:35], s15 offen offset:1056 lds
    buffer_load_dwordx4 v226, s[32:35], s16 offen offset:2112 lds
    buffer_load_dwordx4 v227, s[32:35], s17 offen offset:3168 lds
    s_mov_b32 s36, s20
    s_mov_b32 s37, s21
    s_mov_b32 s38, 2620000
    s_mov_b32 s39, 0x00020000
    s_mov_b32 s92, 3216550459
    s_mov_b32 s93, 3216550459
    s_mov_b32 s61, 1
    s_movk_i32 s63, 272
    s_cmp_lg_u32 s62, 0
    s_cbranch_scc1 .K2_SLOW
.K2_MAIN:
    s_cmp_eq_u32 s59, 0
    s_cbranch_scc1 .K2_EMPTY
    s_mov_b32 s60, s59
    ds_read_b128 v[160:163], v216 offset:0
    ds_read_b128 v[112:115], v223
    ds_read_b128 v[116:119], v223
    ds_read_b128 v[224:227], v218 offset:128
    v_lshlrev_b32 v228, 4, v221
    s_waitcnt vmcnt(4)
    ds_read_b128 v[172:175], v219 offset:0
    ds_read_b128 v[176:179], v219 offset:32
    ds_read_b128 v[180:183], v219 offset:64
    ds_read_b128 v[184:187], v219 offset:96
    s_waitcnt lgkmcnt(4)
    v_mfma_f32_32x32x16_bf16 v[64:79], v[160:163], v[200:203], 0
    v_mfma_f32_32x32x16_bf16 v[80:95], v[160:163], v[204:207], 0
    v_add_u32 v224, v224, v220
    v_add_u32 v225, v225, v220
    v_add_u32 v226, v226, v220
    v_add_u32 v227, v227, v220
    s_waitcnt lgkmcnt(2)
    v_mfma_f32_32x32x16_bf16 v[64:79], v[172:175], v[188:191], v[64:79]
    v_mfma_f32_32x32x16_bf16 v[64:79], v[176:179], v[192:195], v[64:79]
    s_waitcnt lgkmcnt(0)
    v_mfma_f32_32x32x16_bf16 v[80:95], v[180:183], v[188:191], v[80:95]
    s_cmp_le_u32 s60, 32
    s_cbranch_scc1 .K2_NOG1
    s_mov_b32 m0, s68
    s_nop 0
    buffer_load_dwordx4 v224, s[32:35], s64 offen offset:0 lds
    buffer_load_dwordx4 v225, s[32:35], s65 offen offset:1056 lds
    buffer_load_dwordx4 v226, s[32:35], s66 offen offset:2112 lds
    buffer_load_dwordx4 v227, s[32:35], s67 offen offset:3168 lds
.K2_NOG1:
    s_nop 7
    v_exp_f32 v128, v64
    v_exp_f32 v129, v65
    v_exp_f32 v130, v66
    v_mfma_f32_32x32x16_bf16 v[80:95], v[184:187], v[192:195], v[80:95]
    v_exp_f32 v131, v67
    v_exp_f32 v132, v68
    v_exp_f32 v133, v69
    v_exp_f32 v134, v70
    v_exp_f32 v135, v71
    v_exp_f32 v136, v72
    v_exp_f32 v137, v73
    v_exp_f32 v138, v74
    v_exp_f32 v139, v75
    v_exp_f32 v140, v76
    v_exp_f32 v141, v77
    v_exp_f32 v142, v78
    v_exp_f32 v143, v79
    s_nop 1
    v_mfma_f32_32x32x16_bf16 v[128:143], v[196:199], v[196:199], v[128:143]
    s_waitcnt vmcnt(4)
    s_cbranch_scc0 .K2_WF
    s_waitcnt vmcnt(0)
.K2_WF:
    ds_read_b128 v[172:175], v219 offset:4224
    ds_read_b128 v[176:179], v219 offset:4256
    buffer_load_dwordx4 v[240:243], v228, s[24:27], s7 offen offset:0
    buffer_load_dwordx4 v[244:247], v228, s[24:27], s7 offen offset:1024
    buffer_load_dwordx4 v[248:251], v228, s[24:27], s7 offen offset:2048
    buffer_load_dwordx4 v[252:255], v228, s[24:27], s7 offen offset:3072
    s_nop 3
.K2_LOOP:
    s_cmp_le_u32 s60, 32
    s_cbranch_scc1 .K2_LASTT
    s_setprio 2
    s_cmp_gt_u32 s60, 64
    s_cbranch_scc1 .K2_PR
    s_setprio 1
.K2_PR:
    v_mfma_f32_32x32x16_bf16 v[48:63], v[112:115], v[164:167], v[48:63]
    v_exp_f32 v144, v80
    v_exp_f32 v145, v81
    v_exp_f32 v146, v82
    v_exp_f32 v147, v83
    v_mfma_f32_32x32x16_bf16 v[48:63], v[116:119], v[168:171], v[48:63]
    v_exp_f32 v148, v84
    v_exp_f32 v149, v85
    ds_read_b128 v[180:183], v219 offset:4288
    ds_read_b128 v[184:187], v219 offset:4320
    v_exp_f32 v150, v86
    v_exp_f32 v151, v87
    v_xor_b32 v229, 32, v217
    ds_read_b64_tr_b16 v[164:165], v217 offset:0
    ds_read_b64_tr_b16 v[168:169], v217 offset:1024
    ds_read_b64_tr_b16 v[166:167], v229 offset:512
    ds_read_b64_tr_b16 v[170:171], v229 offset:1536
    v_exp_f32 v152, v88
    v_exp_f32 v153, v89
    v_exp_f32 v154, v90
    v_exp_f32 v155, v91
    v_exp_f32 v156, v92
    v_exp_f32 v157, v93
    v_exp_f32 v158, v94
    v_exp_f32 v159, v95
    s_nop 1
    v_mfma_f32_32x32x16_bf16 v[144:159], v[196:199], v[196:199], v[144:159]
    v_rcp_f32 v128, v128
    v_rcp_f32 v129, v129
    s_waitcnt lgkmcnt(6)
    v_rcp_f32 v130, v130
    v_mfma_f32_32x32x16_bf16 v[96:111], v[160:163], v[208:211], 0
    v_rcp_f32 v131, v131
    v_rcp_f32 v132, v132
    v_rcp_f32 v133, v133
    v_rcp_f32 v134, v134
    v_mfma_f32_32x32x16_bf16 v[96:111], v[172:175], v[188:191], v[96:111]
    v_rcp_f32 v135, v135
    v_rcp_f32 v136, v136
    v_rcp_f32 v137, v137
    v_rcp_f32 v138, v138
    v_mfma_f32_32x32x16_bf16 v[96:111], v[176:179], v[192:195], v[96:111]
    v_rcp_f32 v139, v139
    s_waitcnt lgkmcnt(4)
    s_mov_b32 m0, s57
    s_nop 0
    buffer_load_dwordx4 v224, s[32:35], s14 offen offset:0 lds
    buffer_load_dwordx4 v225, s[32:35], s15 offen offset:1056 lds
    buffer_load_dwordx4 v226, s[32:35], s16 offen offset:2112 lds
    buffer_load_dwordx4 v227, s[32:35], s17 offen offset:3168 lds
    v_rcp_f32 v140, v140
    v_rcp_f32 v141, v141
    v_rcp_f32 v142, v142
    v_rcp_f32 v143, v143
    v_pk_mul_f32 v[128:129], v[128:129], v[64:65]
    v_pk_mul_f32 v[130:131], v[130:131], v[66:67]
    v_pk_mul_f32 v[132:133], v[132:133], v[68:69]
    v_pk_mul_f32 v[134:135], v[134:135], v[70:71]
    v_pk_mul_f32 v[136:137], v[136:137], v[72:73]
    v_pk_mul_f32 v[138:139], v[138:139], v[74:75]
    v_pk_mul_f32 v[140:141], v[140:141], v[76:77]
    v_pk_mul_f32 v[142:143], v[142:143], v[78:79]
    v_cvt_pk_bf16_f32 v64, v128, v129
    v_cvt_pk_bf16_f32 v65, v130, v131
    v_cvt_pk_bf16_f32 v66, v132, v133
    v_cvt_pk_bf16_f32 v67, v134, v135
    v_cvt_pk_bf16_f32 v68, v136, v137
    v_cvt_pk_bf16_f32 v69, v138, v139
    v_cvt_pk_bf16_f32 v70, v140, v141
    v_cvt_pk_bf16_f32 v71, v142, v143
    s_waitcnt lgkmcnt(0)
    v_mfma_f32_32x32x16_bf16 v[0:15], v[64:67], v[164:167], v[0:15]
    v_exp_f32 v128, v96
    v_exp_f32 v129, v97
    v_exp_f32 v130, v98
    v_exp_f32 v131, v99
    v_mfma_f32_32x32x16_bf16 v[0:15], v[68:71], v[168:171], v[0:15]
    v_exp_f32 v132, v100
    v_exp_f32 v133, v101
    s_waitcnt vmcnt(4)
    ds_read_b128 v[172:175], v219 offset:0
    ds_read_b128 v[176:179], v219 offset:32
    v_exp_f32 v134, v102
    v_exp_f32 v135, v103
    v_exp_f32 v136, v104
    v_exp_f32 v137, v105
    v_exp_f32 v138, v106
    v_exp_f32 v139, v107
    v_exp_f32 v140, v108
    v_exp_f32 v141, v109
    v_exp_f32 v142, v110
    v_exp_f32 v143, v111
    s_nop 1
    v_mfma_f32_32x32x16_bf16 v[128:143], v[196:199], v[196:199], v[128:143]
    v_rcp_f32 v144, v144
    v_rcp_f32 v145, v145
    v_rcp_f32 v146, v146
    v_mfma_f32_32x32x16_bf16 v[112:127], v[160:163], v[212:215], 0
    v_rcp_f32 v147, v147
    v_rcp_f32 v148, v148
    ds_read_b128 v[160:163], v216 offset:2048
    v_rcp_f32 v149, v149
    v_rcp_f32 v150, v150
    v_mfma_f32_32x32x16_bf16 v[112:127], v[180:183], v[188:191], v[112:127]
    v_rcp_f32 v151, v151
    v_rcp_f32 v152, v152
    v_rcp_f32 v153, v153
    v_rcp_f32 v154, v154
    v_mfma_f32_32x32x16_bf16 v[112:127], v[184:187], v[192:195], v[112:127]
    v_rcp_f32 v155, v155
    v_rcp_f32 v156, v156
    v_rcp_f32 v157, v157
    v_rcp_f32 v158, v158
    v_rcp_f32 v159, v159
    v_pk_mul_f32 v[144:145], v[144:145], v[80:81]
    v_pk_mul_f32 v[146:147], v[146:147], v[82:83]
    v_pk_mul_f32 v[148:149], v[148:149], v[84:85]
    v_pk_mul_f32 v[150:151], v[150:151], v[86:87]
    v_pk_mul_f32 v[152:153], v[152:153], v[88:89]
    v_pk_mul_f32 v[154:155], v[154:155], v[90:91]
    v_pk_mul_f32 v[156:157], v[156:157], v[92:93]
    v_pk_mul_f32 v[158:159], v[158:159], v[94:95]
    v_cvt_pk_bf16_f32 v80, v144, v145
    v_cvt_pk_bf16_f32 v81, v146, v147
    v_cvt_pk_bf16_f32 v82, v148, v149
    v_cvt_pk_bf16_f32 v83, v150, v151
    v_cvt_pk_bf16_f32 v84, v152, v153
    v_cvt_pk_bf16_f32 v85, v154, v155
    v_cvt_pk_bf16_f32 v86, v156, v157
    v_cvt_pk_bf16_f32 v87, v158, v159
    v_add_u32 v216, 2048, v216
    v_add_u32 v218, 128, v218
    s_sub_u32 s60, s60, 32
    v_mfma_f32_32x32x16_bf16 v[16:31], v[80:83], v[164:167], v[16:31]
    v_exp_f32 v144, v112
    v_exp_f32 v145, v113
    v_exp_f32 v146, v114
    v_exp_f32 v147, v115
    v_mfma_f32_32x32x16_bf16 v[16:31], v[84:87], v[168:171], v[16:31]
    v_exp_f32 v148, v116
    v_exp_f32 v149, v117
    ds_read_b128 v[180:183], v219 offset:64
    ds_read_b128 v[184:187], v219 offset:96
    v_exp_f32 v150, v118
    v_exp_f32 v151, v119
    ds_read_b128 v[224:227], v218 offset:128
    v_exp_f32 v152, v120
    v_exp_f32 v153, v121
    v_exp_f32 v154, v122
    v_exp_f32 v155, v123
    v_exp_f32 v156, v124
    v_exp_f32 v157, v125
    v_exp_f32 v158, v126
    v_exp_f32 v159, v127
    s_nop 1
    v_mfma_f32_32x32x16_bf16 v[144:159], v[196:199], v[196:199], v[144:159]
    v_rcp_f32 v128, v128
    v_rcp_f32 v129, v129
    s_waitcnt lgkmcnt(3)
    v_rcp_f32 v130, v130
    v_mfma_f32_32x32x16_bf16 v[64:79], v[160:163], v[200:203], 0
    v_rcp_f32 v131, v131
    v_rcp_f32 v132, v132
    v_rcp_f32 v133, v133
    v_rcp_f32 v134, v134
    v_mfma_f32_32x32x16_bf16 v[64:79], v[172:175], v[188:191], v[64:79]
    v_rcp_f32 v135, v135
    v_rcp_f32 v136, v136
    v_rcp_f32 v137, v137
    v_rcp_f32 v138, v138
    v_mfma_f32_32x32x16_bf16 v[64:79], v[176:179], v[192:195], v[64:79]
    v_rcp_f32 v139, v139
    v_rcp_f32 v140, v140
    v_rcp_f32 v141, v141
    v_rcp_f32 v142, v142
    v_rcp_f32 v143, v143
    s_waitcnt lgkmcnt(0)
    s_cmp_le_u32 s60, 32
    s_cbranch_scc1 .K2_NOG2
    v_add_u32 v224, v224, v220
    v_add_u32 v225, v225, v220
    v_add_u32 v226, v226, v220
    v_add_u32 v227, v227, v220
    s_mov_b32 m0, s68
    s_nop 0
    buffer_load_dwordx4 v224, s[32:35], s64 offen offset:0 lds
    buffer_load_dwordx4 v225, s[32:35], s65 offen offset:1056 lds
    buffer_load_dwordx4 v226, s[32:35], s66 offen offset:2112 lds
    buffer_load_dwordx4 v227, s[32:35], s67 offen offset:3168 lds
.K2_NOG2:
    v_pk_mul_f32 v[128:129], v[128:129], v[96:97]
    v_pk_mul_f32 v[130:131], v[130:131], v[98:99]
    v_pk_mul_f32 v[132:133], v[132:133], v[100:101]
    v_pk_mul_f32 v[134:135], v[134:135], v[102:103]
    v_pk_mul_f32 v[136:137], v[136:137], v[104:105]
    v_pk_mul_f32 v[138:139], v[138:139], v[106:107]
    v_pk_mul_f32 v[140:141], v[140:141], v[108:109]
    v_pk_mul_f32 v[142:143], v[142:143], v[110:111]
    v_cvt_pk_bf16_f32 v96, v128, v129
    v_cvt_pk_bf16_f32 v97, v130, v131
    v_cvt_pk_bf16_f32 v98, v132, v133
    v_cvt_pk_bf16_f32 v99, v134, v135
    v_cvt_pk_bf16_f32 v100, v136, v137
    v_cvt_pk_bf16_f32 v101, v138, v139
    v_cvt_pk_bf16_f32 v102, v140, v141
    v_cvt_pk_bf16_f32 v103, v142, v143
    v_mfma_f32_32x32x16_bf16 v[32:47], v[96:99], v[164:167], v[32:47]
    v_exp_f32 v128, v64
    v_exp_f32 v129, v65
    v_exp_f32 v130, v66
    v_exp_f32 v131, v67
    v_mfma_f32_32x32x16_bf16 v[32:47], v[100:103], v[168:171], v[32:47]
    v_exp_f32 v132, v68
    v_exp_f32 v133, v69
    s_waitcnt vmcnt(4)
    s_cbranch_scc0 .K2_W3
    s_waitcnt vmcnt(0)
.K2_W3:
    ds_read_b128 v[172:175], v219 offset:4224
    ds_read_b128 v[176:179], v219 offset:4256
    v_exp_f32 v134, v70
    v_exp_f32 v135, v71
    v_exp_f32 v136, v72
    v_exp_f32 v137, v73
    v_exp_f32 v138, v74
    v_exp_f32 v139, v75
    v_exp_f32 v140, v76
    v_exp_f32 v141, v77
    v_exp_f32 v142, v78
    v_exp_f32 v143, v79
    s_nop 1
    v_mfma_f32_32x32x16_bf16 v[128:143], v[196:199], v[196:199], v[128:143]
    v_rcp_f32 v144, v144
    v_rcp_f32 v145, v145
    v_rcp_f32 v146, v146
    v_mfma_f32_32x32x16_bf16 v[80:95], v[160:163], v[204:207], 0
    v_rcp_f32 v147, v147
    v_rcp_f32 v148, v148
    v_rcp_f32 v149, v149
    v_rcp_f32 v150, v150
    v_mfma_f32_32x32x16_bf16 v[80:95], v[180:183], v[188:191], v[80:95]
    v_rcp_f32 v151, v151
    v_rcp_f32 v152, v152
    v_rcp_f32 v153, v153
    v_rcp_f32 v154, v154
    v_mfma_f32_32x32x16_bf16 v[80:95], v[184:187], v[192:195], v[80:95]
    v_rcp_f32 v155, v155
    v_rcp_f32 v156, v156
    v_rcp_f32 v157, v157
    v_rcp_f32 v158, v158
    v_rcp_f32 v159, v159
    v_pk_mul_f32 v[144:145], v[144:145], v[112:113]
    v_pk_mul_f32 v[146:147], v[146:147], v[114:115]
    v_pk_mul_f32 v[148:149], v[148:149], v[116:117]
    v_pk_mul_f32 v[150:151], v[150:151], v[118:119]
    v_pk_mul_f32 v[152:153], v[152:153], v[120:121]
    v_pk_mul_f32 v[154:155], v[154:155], v[122:123]
    v_pk_mul_f32 v[156:157], v[156:157], v[124:125]
    v_pk_mul_f32 v[158:159], v[158:159], v[126:127]
    v_cvt_pk_bf16_f32 v112, v144, v145
    v_cvt_pk_bf16_f32 v113, v146, v147
    v_cvt_pk_bf16_f32 v114, v148, v149
    v_cvt_pk_bf16_f32 v115, v150, v151
    v_cvt_pk_bf16_f32 v116, v152, v153
    v_cvt_pk_bf16_f32 v117, v154, v155
    v_cvt_pk_bf16_f32 v118, v156, v157
    v_cvt_pk_bf16_f32 v119, v158, v159
    v_add_u32 v217, 2048, v217
    s_branch .K2_LOOP
.K2_LASTT:
    s_setprio 0
    s_cmp_gt_u32 s60, 24
    s_cbranch_scc1 .K2_Q4
    s_cmp_gt_u32 s60, 16
    s_cbranch_scc1 .K2_Q3
    s_cmp_gt_u32 s60, 8
    s_cbranch_scc1 .K2_Q2
.K2_Q1:
    s_setprio 3
    s_nop 1
    v_mfma_f32_32x32x16_bf16 v[48:63], v[112:115], v[164:167], v[48:63]
    v_exp_f32 v144, v80
    v_exp_f32 v145, v81
    v_exp_f32 v146, v82
    v_exp_f32 v147, v83
    v_mfma_f32_32x32x16_bf16 v[48:63], v[116:119], v[168:171], v[48:63]
    ds_read_b128 v[180:183], v219 offset:4288
    ds_read_b128 v[184:187], v219 offset:4320
    v_xor_b32 v229, 32, v217
    ds_read_b64_tr_b16 v[164:165], v217 offset:0
    ds_read_b64_tr_b16 v[168:169], v217 offset:1024
    ds_read_b64_tr_b16 v[166:167], v229 offset:512
    ds_read_b64_tr_b16 v[170:171], v229 offset:1536
    v_mfma_f32_32x32x16_bf16 v[144:159], v[196:199], v[196:199], v[144:159]
    s_waitcnt lgkmcnt(6)
    v_rcp_f32 v128, v128
    v_rcp_f32 v129, v129
    v_rcp_f32 v130, v130
    v_mfma_f32_32x32x16_bf16 v[96:111], v[160:163], v[208:211], 0
    v_rcp_f32 v131, v131
    v_mfma_f32_32x32x16_bf16 v[96:111], v[172:175], v[188:191], v[96:111]
    v_mfma_f32_32x32x16_bf16 v[96:111], v[176:179], v[192:195], v[96:111]
    v_pk_mul_f32 v[128:129], v[128:129], v[64:65]
    v_pk_mul_f32 v[130:131], v[130:131], v[66:67]
    v_cvt_pk_bf16_f32 v64, v128, v129
    v_cvt_pk_bf16_f32 v65, v130, v131
    v_mov_b32 v66, 0
    v_mov_b32 v67, 0
    s_waitcnt lgkmcnt(0)
    s_nop 0
    v_mfma_f32_32x32x16_bf16 v[0:15], v[64:67], v[164:167], v[0:15]
    s_nop 2
    v_exp_f32 v128, v96
    v_exp_f32 v129, v97
    v_exp_f32 v130, v98
    v_exp_f32 v131, v99
    s_nop 1
    v_mfma_f32_32x32x16_bf16 v[128:143], v[196:199], v[196:199], v[128:143]
    v_rcp_f32 v144, v144
    v_rcp_f32 v145, v145
    v_rcp_f32 v146, v146
    v_mfma_f32_32x32x16_bf16 v[112:127], v[160:163], v[212:215], 0
    v_rcp_f32 v147, v147
    v_mfma_f32_32x32x16_bf16 v[112:127], v[180:183], v[188:191], v[112:127]
    v_mfma_f32_32x32x16_bf16 v[112:127], v[184:187], v[192:195], v[112:127]
    v_pk_mul_f32 v[144:145], v[144:145], v[80:81]
    v_pk_mul_f32 v[146:147], v[146:147], v[82:83]
    v_cvt_pk_bf16_f32 v80, v144, v145
    v_cvt_pk_bf16_f32 v81, v146, v147
    v_mov_b32 v82, 0
    v_mov_b32 v83, 0
    s_nop 1
    v_mfma_f32_32x32x16_bf16 v[16:31], v[80:83], v[164:167], v[16:31]
    s_nop 2
    v_exp_f32 v144, v112
    v_exp_f32 v145, v113
    v_exp_f32 v146, v114
    v_exp_f32 v147, v115
    s_nop 1
    v_mfma_f32_32x32x16_bf16 v[144:159], v[196:199], v[196:199], v[144:159]
    s_cmp_eq_u32 s61, 0
    s_cbranch_scc1 .K2_NF1
    v_lshlrev_b32 v228, 4, v221
    buffer_load_dwordx4 v[64:67], v228, s[24:27], s6 offen offset:0
    buffer_load_dwordx4 v[68:71], v228, s[24:27], s6 offen offset:1024
    buffer_load_dwordx4 v[72:75], v228, s[24:27], s6 offen offset:2048
    buffer_load_dwordx4 v[76:79], v228, s[24:27], s6 offen offset:3072
    s_mul_i32 s70, s2, 10240
    s_lshl_b32 s71, s56, 5
    s_add_u32 s74, s70, s71
    s_add_u32 s75, s74, 4096
    s_add_u32 s76, s74, 8192
    buffer_load_dwordx2 v[200:201], v222, s[28:31], s74 offen
    buffer_load_dwordx2 v[202:203], v222, s[28:31], s75 offen
    buffer_load_dwordx2 v[204:205], v222, s[28:31], s76 offen
    s_mul_i32 s70, s58, 80
    v_lshl_add_u32 v216, v221, 2, s70
    ds_read_b32 v206, v216 offset:4348
    v_and_b32 v218, 32, v221
    v_add_u32 v218, 161664, v218
    s_mov_b32 s70, 0xf0f00f0f
    s_mov_b32 s71, 0xf0f00f0f
    v_cndmask_b32 v218, v223, v218, s[70:71]
    ds_read_b128 v[172:175], v218 offset:0
    ds_read_b128 v[176:179], v218 offset:16
    ds_read_b128 v[180:183], v218 offset:64
    ds_read_b128 v[184:187], v218 offset:80
    ds_read_b128 v[188:191], v218 offset:128
    ds_read_b128 v[192:195], v218 offset:144
    ds_read_b128 v[208:211], v218 offset:192
    ds_read_b128 v[212:215], v218 offset:208
.K2_NF1:
    v_rcp_f32 v128, v128
    v_rcp_f32 v129, v129
    v_rcp_f32 v130, v130
    v_rcp_f32 v131, v131
    v_pk_mul_f32 v[128:129], v[128:129], v[96:97]
    v_pk_mul_f32 v[130:131], v[130:131], v[98:99]
    v_cvt_pk_bf16_f32 v96, v128, v129
    v_cvt_pk_bf16_f32 v97, v130, v131
    v_mov_b32 v98, 0
    v_mov_b32 v99, 0
    s_nop 1
    v_mfma_f32_32x32x16_bf16 v[32:47], v[96:99], v[164:167], v[32:47]
    v_rcp_f32 v144, v144
    v_rcp_f32 v145, v145
    v_rcp_f32 v146, v146
    v_rcp_f32 v147, v147
    v_pk_mul_f32 v[144:145], v[144:145], v[112:113]
    v_pk_mul_f32 v[146:147], v[146:147], v[114:115]
    v_cvt_pk_bf16_f32 v112, v144, v145
    v_cvt_pk_bf16_f32 v113, v146, v147
    v_mov_b32 v114, 0
    v_mov_b32 v115, 0
    s_nop 1
    v_mfma_f32_32x32x16_bf16 v[48:63], v[112:115], v[164:167], v[48:63]
    s_branch .K2_DONE
.K2_Q2:
    s_setprio 3
    s_nop 1
    v_mfma_f32_32x32x16_bf16 v[48:63], v[112:115], v[164:167], v[48:63]
    v_exp_f32 v144, v80
    v_exp_f32 v145, v81
    v_exp_f32 v146, v82
    v_exp_f32 v147, v83
    v_mfma_f32_32x32x16_bf16 v[48:63], v[116:119], v[168:171], v[48:63]
    v_exp_f32 v148, v84
    v_exp_f32 v149, v85
    ds_read_b128 v[180:183], v219 offset:4288
    ds_read_b128 v[184:187], v219 offset:4320
    v_exp_f32 v150, v86
    v_exp_f32 v151, v87
    v_xor_b32 v229, 32, v217
    ds_read_b64_tr_b16 v[164:165], v217 offset:0
    ds_read_b64_tr_b16 v[168:169], v217 offset:1024
    ds_read_b64_tr_b16 v[166:167], v229 offset:512
    ds_read_b64_tr_b16 v[170:171], v229 offset:1536
    v_mfma_f32_32x32x16_bf16 v[144:159], v[196:199], v[196:199], v[144:159]
    s_waitcnt lgkmcnt(6)
    v_rcp_f32 v128, v128
    v_rcp_f32 v129, v129
    v_rcp_f32 v130, v130
    v_mfma_f32_32x32x16_bf16 v[96:111], v[160:163], v[208:211], 0
    v_rcp_f32 v131, v131
    v_rcp_f32 v132, v132
    v_rcp_f32 v133, v133
    v_rcp_f32 v134, v134
    v_mfma_f32_32x32x16_bf16 v[96:111], v[172:175], v[188:191], v[96:111]
    v_rcp_f32 v135, v135
    v_mfma_f32_32x32x16_bf16 v[96:111], v[176:179], v[192:195], v[96:111]
    v_pk_mul_f32 v[128:129], v[128:129], v[64:65]
    v_pk_mul_f32 v[130:131], v[130:131], v[66:67]
    v_pk_mul_f32 v[132:133], v[132:133], v[68:69]
    v_pk_mul_f32 v[134:135], v[134:135], v[70:71]
    v_cvt_pk_bf16_f32 v64, v128, v129
    v_cvt_pk_bf16_f32 v65, v130, v131
    v_cvt_pk_bf16_f32 v66, v132, v133
    v_cvt_pk_bf16_f32 v67, v134, v135
    s_waitcnt lgkmcnt(0)
    s_nop 0
    v_mfma_f32_32x32x16_bf16 v[0:15], v[64:67], v[164:167], v[0:15]
    s_nop 0
    v_exp_f32 v128, v96
    v_exp_f32 v129, v97
    v_exp_f32 v130, v98
    v_exp_f32 v131, v99
    v_exp_f32 v132, v100
    v_exp_f32 v133, v101
    v_exp_f32 v134, v102
    v_exp_f32 v135, v103
    s_nop 1
    v_mfma_f32_32x32x16_bf16 v[128:143], v[196:199], v[196:199], v[128:143]
    v_rcp_f32 v144, v144
    v_rcp_f32 v145, v145
    v_rcp_f32 v146, v146
    v_mfma_f32_32x32x16_bf16 v[112:127], v[160:163], v[212:215], 0
    v_rcp_f32 v147, v147
    v_rcp_f32 v148, v148
    v_rcp_f32 v149, v149
    v_rcp_f32 v150, v150
    v_mfma_f32_32x32x16_bf16 v[112:127], v[180:183], v[188:191], v[112:127]
    v_rcp_f32 v151, v151
    v_mfma_f32_32x32x16_bf16 v[112:127], v[184:187], v[192:195], v[112:127]
    v_pk_mul_f32 v[144:145], v[144:145], v[80:81]
    v_pk_mul_f32 v[146:147], v[146:147], v[82:83]
    v_pk_mul_f32 v[148:149], v[148:149], v[84:85]
    v_pk_mul_f32 v[150:151], v[150:151], v[86:87]
    v_cvt_pk_bf16_f32 v80, v144, v145
    v_cvt_pk_bf16_f32 v81, v146, v147
    v_cvt_pk_bf16_f32 v82, v148, v149
    v_cvt_pk_bf16_f32 v83, v150, v151
    s_nop 1
    v_mfma_f32_32x32x16_bf16 v[16:31], v[80:83], v[164:167], v[16:31]
    s_nop 0
    v_exp_f32 v144, v112
    v_exp_f32 v145, v113
    v_exp_f32 v146, v114
    v_exp_f32 v147, v115
    v_exp_f32 v148, v116
    v_exp_f32 v149, v117
    v_exp_f32 v150, v118
    v_exp_f32 v151, v119
    s_nop 1
    v_mfma_f32_32x32x16_bf16 v[144:159], v[196:199], v[196:199], v[144:159]
    s_cmp_eq_u32 s61, 0
    s_cbranch_scc1 .K2_NF2
    v_lshlrev_b32 v228, 4, v221
    buffer_load_dwordx4 v[64:67], v228, s[24:27], s6 offen offset:0
    buffer_load_dwordx4 v[68:71], v228, s[24:27], s6 offen offset:1024
    buffer_load_dwordx4 v[72:75], v228, s[24:27], s6 offen offset:2048
    buffer_load_dwordx4 v[76:79], v228, s[24:27], s6 offen offset:3072
    s_mul_i32 s70, s2, 10240
    s_lshl_b32 s71, s56, 5
    s_add_u32 s74, s70, s71
    s_add_u32 s75, s74, 4096
    s_add_u32 s76, s74, 8192
    buffer_load_dwordx2 v[200:201], v222, s[28:31], s74 offen
    buffer_load_dwordx2 v[202:203], v222, s[28:31], s75 offen
    buffer_load_dwordx2 v[204:205], v222, s[28:31], s76 offen
    s_mul_i32 s70, s58, 80
    v_lshl_add_u32 v216, v221, 2, s70
    ds_read_b32 v206, v216 offset:4348
    v_and_b32 v218, 32, v221
    v_add_u32 v218, 161664, v218
    s_mov_b32 s70, 0xf0f00f0f
    s_mov_b32 s71, 0xf0f00f0f
    v_cndmask_b32 v218, v223, v218, s[70:71]
    ds_read_b128 v[172:175], v218 offset:0
    ds_read_b128 v[176:179], v218 offset:16
    ds_read_b128 v[180:183], v218 offset:64
    ds_read_b128 v[184:187], v218 offset:80
    ds_read_b128 v[188:191], v218 offset:128
    ds_read_b128 v[192:195], v218 offset:144
    ds_read_b128 v[208:211], v218 offset:192
    ds_read_b128 v[212:215], v218 offset:208
.K2_NF2:
    v_rcp_f32 v128, v128
    v_rcp_f32 v129, v129
    v_rcp_f32 v130, v130
    v_rcp_f32 v131, v131
    v_rcp_f32 v132, v132
    v_rcp_f32 v133, v133
    v_rcp_f32 v134, v134
    v_rcp_f32 v135, v135
    v_pk_mul_f32 v[128:129], v[128:129], v[96:97]
    v_pk_mul_f32 v[130:131], v[130:131], v[98:99]
    v_pk_mul_f32 v[132:133], v[132:133], v[100:101]
    v_pk_mul_f32 v[134:135], v[134:135], v[102:103]
    v_cvt_pk_bf16_f32 v96, v128, v129
    v_cvt_pk_bf16_f32 v97, v130, v131
    v_cvt_pk_bf16_f32 v98, v132, v133
    v_cvt_pk_bf16_f32 v99, v134, v135
    s_nop 1
    v_mfma_f32_32x32x16_bf16 v[32:47], v[96:99], v[164:167], v[32:47]
    v_rcp_f32 v144, v144
    v_rcp_f32 v145, v145
    v_rcp_f32 v146, v146
    v_rcp_f32 v147, v147
    v_rcp_f32 v148, v148
    v_rcp_f32 v149, v149
    v_rcp_f32 v150, v150
    v_rcp_f32 v151, v151
    v_pk_mul_f32 v[144:145], v[144:145], v[112:113]
    v_pk_mul_f32 v[146:147], v[146:147], v[114:115]
    v_pk_mul_f32 v[148:149], v[148:149], v[116:117]
    v_pk_mul_f32 v[150:151], v[150:151], v[118:119]
    v_cvt_pk_bf16_f32 v112, v144, v145
    v_cvt_pk_bf16_f32 v113, v146, v147
    v_cvt_pk_bf16_f32 v114, v148, v149
    v_cvt_pk_bf16_f32 v115, v150, v151
    s_nop 1
    v_mfma_f32_32x32x16_bf16 v[48:63], v[112:115], v[164:167], v[48:63]
    s_branch .K2_DONE
.K2_Q3:
    s_nop 1
    v_mfma_f32_32x32x16_bf16 v[48:63], v[112:115], v[164:167], v[48:63]
    v_exp_f32 v144, v80
    v_exp_f32 v145, v81
    v_exp_f32 v146, v82
    v_exp_f32 v147, v83
    v_mfma_f32_32x32x16_bf16 v[48:63], v[116:119], v[168:171], v[48:63]
    v_exp_f32 v148, v84
    v_exp_f32 v149, v85
    ds_read_b128 v[180:183], v219 offset:4288
    ds_read_b128 v[184:187], v219 offset:4320
    v_exp_f32 v150, v86
    v_exp_f32 v151, v87
    v_xor_b32 v229, 32, v217
    ds_read_b64_tr_b16 v[164:165], v217 offset:0
    ds_read_b64_tr_b16 v[168:169], v217 offset:1024
    ds_read_b64_tr_b16 v[166:167], v229 offset:512
    ds_read_b64_tr_b16 v[170:171], v229 offset:1536
    v_exp_f32 v152, v88
    v_exp_f32 v153, v89
    v_exp_f32 v154, v90
    v_exp_f32 v155, v91
    s_nop 1
    v_mfma_f32_32x32x16_bf16 v[144:159], v[196:199], v[196:199], v[144:159]
    s_waitcnt lgkmcnt(6)
    v_rcp_f32 v128, v128
    v_rcp_f32 v129, v129
    v_rcp_f32 v130, v130
    v_mfma_f32_32x32x16_bf16 v[96:111], v[160:163], v[208:211], 0
    v_rcp_f32 v131, v131
    v_rcp_f32 v132, v132
    v_rcp_f32 v133, v133
    v_rcp_f32 v134, v134
    v_mfma_f32_32x32x16_bf16 v[96:111], v[172:175], v[188:191], v[96:111]
    v_rcp_f32 v135, v135
    v_rcp_f32 v136, v136
    v_rcp_f32 v137, v137
    v_rcp_f32 v138, v138
    v_mfma_f32_32x32x16_bf16 v[96:111], v[176:179], v[192:195], v[96:111]
    v_rcp_f32 v139, v139
    v_pk_mul_f32 v[128:129], v[128:129], v[64:65]
    v_pk_mul_f32 v[130:131], v[130:131], v[66:67]
    v_pk_mul_f32 v[132:133], v[132:133], v[68:69]
    v_pk_mul_f32 v[134:135], v[134:135], v[70:71]
    v_pk_mul_f32 v[136:137], v[136:137], v[72:73]
    v_pk_mul_f32 v[138:139], v[138:139], v[74:75]
    v_cvt_pk_bf16_f32 v64, v128, v129
    v_cvt_pk_bf16_f32 v65, v130, v131
    v_cvt_pk_bf16_f32 v66, v132, v133
    v_cvt_pk_bf16_f32 v67, v134, v135
    v_cvt_pk_bf16_f32 v68, v136, v137
    v_cvt_pk_bf16_f32 v69, v138, v139
    v_mov_b32 v70, 0
    v_mov_b32 v71, 0
    s_waitcnt lgkmcnt(0)
    v_mfma_f32_32x32x16_bf16 v[0:15], v[64:67], v[164:167], v[0:15]
    v_exp_f32 v128, v96
    v_exp_f32 v129, v97
    v_exp_f32 v130, v98
    v_exp_f32 v131, v99
    v_mfma_f32_32x32x16_bf16 v[0:15], v[68:71], v[168:171], v[0:15]
    v_exp_f32 v132, v100
    v_exp_f32 v133, v101
    v_exp_f32 v134, v102
    v_exp_f32 v135, v103
    v_exp_f32 v136, v104
    v_exp_f32 v137, v105
    v_exp_f32 v138, v106
    v_exp_f32 v139, v107
    s_nop 1
    v_mfma_f32_32x32x16_bf16 v[128:143], v[196:199], v[196:199], v[128:143]
    v_rcp_f32 v144, v144
    v_rcp_f32 v145, v145
    v_rcp_f32 v146, v146
    v_mfma_f32_32x32x16_bf16 v[112:127], v[160:163], v[212:215], 0
    v_rcp_f32 v147, v147
    v_rcp_f32 v148, v148
    v_rcp_f32 v149, v149
    v_rcp_f32 v150, v150
    v_mfma_f32_32x32x16_bf16 v[112:127], v[180:183], v[188:191], v[112:127]
    v_rcp_f32 v151, v151
    v_rcp_f32 v152, v152
    v_rcp_f32 v153, v153
    v_rcp_f32 v154, v154
    v_mfma_f32_32x32x16_bf16 v[112:127], v[184:187], v[192:195], v[112:127]
    v_rcp_f32 v155, v155
    v_pk_mul_f32 v[144:145], v[144:145], v[80:81]
    v_pk_mul_f32 v[146:147], v[146:147], v[82:83]
    v_pk_mul_f32 v[148:149], v[148:149], v[84:85]
    v_pk_mul_f32 v[150:151], v[150:151], v[86:87]
    v_pk_mul_f32 v[152:153], v[152:153], v[88:89]
    v_pk_mul_f32 v[154:155], v[154:155], v[90:91]
    v_cvt_pk_bf16_f32 v80, v144, v145
    v_cvt_pk_bf16_f32 v81, v146, v147
    v_cvt_pk_bf16_f32 v82, v148, v149
    v_cvt_pk_bf16_f32 v83, v150, v151
    v_cvt_pk_bf16_f32 v84, v152, v153
    v_cvt_pk_bf16_f32 v85, v154, v155
    v_mov_b32 v86, 0
    v_mov_b32 v87, 0
    v_mfma_f32_32x32x16_bf16 v[16:31], v[80:83], v[164:167], v[16:31]
    v_exp_f32 v144, v112
    v_exp_f32 v145, v113
    v_exp_f32 v146, v114
    v_exp_f32 v147, v115
    v_mfma_f32_32x32x16_bf16 v[16:31], v[84:87], v[168:171], v[16:31]
    v_exp_f32 v148, v116
    v_exp_f32 v149, v117
    v_exp_f32 v150, v118
    v_exp_f32 v151, v119
    v_exp_f32 v152, v120
    v_exp_f32 v153, v121
    v_exp_f32 v154, v122
    v_exp_f32 v155, v123
    s_nop 1
    v_mfma_f32_32x32x16_bf16 v[144:159], v[196:199], v[196:199], v[144:159]
    s_cmp_eq_u32 s61, 0
    s_cbranch_scc1 .K2_NF3
    v_lshlrev_b32 v228, 4, v221
    buffer_load_dwordx4 v[64:67], v228, s[24:27], s6 offen offset:0
    buffer_load_dwordx4 v[68:71], v228, s[24:27], s6 offen offset:1024
    buffer_load_dwordx4 v[72:75], v228, s[24:27], s6 offen offset:2048
    buffer_load_dwordx4 v[76:79], v228, s[24:27], s6 offen offset:3072
    s_mul_i32 s70, s2, 10240
    s_lshl_b32 s71, s56, 5
    s_add_u32 s74, s70, s71
    s_add_u32 s75, s74, 4096
    s_add_u32 s76, s74, 8192
    buffer_load_dwordx2 v[200:201], v222, s[28:31], s74 offen
    buffer_load_dwordx2 v[202:203], v222, s[28:31], s75 offen
    buffer_load_dwordx2 v[204:205], v222, s[28:31], s76 offen
    s_mul_i32 s70, s58, 80
    v_lshl_add_u32 v216, v221, 2, s70
    ds_read_b32 v206, v216 offset:4348
    v_and_b32 v218, 32, v221
    v_add_u32 v218, 161664, v218
    s_mov_b32 s70, 0xf0f00f0f
    s_mov_b32 s71, 0xf0f00f0f
    v_cndmask_b32 v218, v223, v218, s[70:71]
    ds_read_b128 v[172:175], v218 offset:0
    ds_read_b128 v[176:179], v218 offset:16
    ds_read_b128 v[180:183], v218 offset:64
    ds_read_b128 v[184:187], v218 offset:80
    ds_read_b128 v[188:191], v218 offset:128
    ds_read_b128 v[192:195], v218 offset:144
    ds_read_b128 v[208:211], v218 offset:192
    ds_read_b128 v[212:215], v218 offset:208
.K2_NF3:
    v_rcp_f32 v128, v128
    v_rcp_f32 v129, v129
    v_rcp_f32 v130, v130
    v_rcp_f32 v131, v131
    v_rcp_f32 v132, v132
    v_rcp_f32 v133, v133
    v_rcp_f32 v134, v134
    v_rcp_f32 v135, v135
    v_rcp_f32 v136, v136
    v_rcp_f32 v137, v137
    v_rcp_f32 v138, v138
    v_rcp_f32 v139, v139
    v_pk_mul_f32 v[128:129], v[128:129], v[96:97]
    v_pk_mul_f32 v[130:131], v[130:131], v[98:99]
    v_pk_mul_f32 v[132:133], v[132:133], v[100:101]
    v_pk_mul_f32 v[134:135], v[134:135], v[102:103]
    v_pk_mul_f32 v[136:137], v[136:137], v[104:105]
    v_pk_mul_f32 v[138:139], v[138:139], v[106:107]
    v_cvt_pk_bf16_f32 v96, v128, v129
    v_cvt_pk_bf16_f32 v97, v130, v131
    v_cvt_pk_bf16_f32 v98, v132, v133
    v_cvt_pk_bf16_f32 v99, v134, v135
    v_cvt_pk_bf16_f32 v100, v136, v137
    v_cvt_pk_bf16_f32 v101, v138, v139
    v_mov_b32 v102, 0
    v_mov_b32 v103, 0
    v_mfma_f32_32x32x16_bf16 v[32:47], v[96:99], v[164:167], v[32:47]
    s_nop 0
    v_mfma_f32_32x32x16_bf16 v[32:47], v[100:103], v[168:171], v[32:47]
    v_rcp_f32 v144, v144
    v_rcp_f32 v145, v145
    v_rcp_f32 v146, v146
    v_rcp_f32 v147, v147
    v_rcp_f32 v148, v148
    v_rcp_f32 v149, v149
    v_rcp_f32 v150, v150
    v_rcp_f32 v151, v151
    v_rcp_f32 v152, v152
    v_rcp_f32 v153, v153
    v_rcp_f32 v154, v154
    v_rcp_f32 v155, v155
    v_pk_mul_f32 v[144:145], v[144:145], v[112:113]
    v_pk_mul_f32 v[146:147], v[146:147], v[114:115]
    v_pk_mul_f32 v[148:149], v[148:149], v[116:117]
    v_pk_mul_f32 v[150:151], v[150:151], v[118:119]
    v_pk_mul_f32 v[152:153], v[152:153], v[120:121]
    v_pk_mul_f32 v[154:155], v[154:155], v[122:123]
    v_cvt_pk_bf16_f32 v112, v144, v145
    v_cvt_pk_bf16_f32 v113, v146, v147
    v_cvt_pk_bf16_f32 v114, v148, v149
    v_cvt_pk_bf16_f32 v115, v150, v151
    v_cvt_pk_bf16_f32 v116, v152, v153
    v_cvt_pk_bf16_f32 v117, v154, v155
    v_mov_b32 v118, 0
    v_mov_b32 v119, 0
    v_mfma_f32_32x32x16_bf16 v[48:63], v[112:115], v[164:167], v[48:63]
    s_nop 0
    v_mfma_f32_32x32x16_bf16 v[48:63], v[116:119], v[168:171], v[48:63]
    s_branch .K2_DONE
.K2_Q4:
    s_nop 1
    v_mfma_f32_32x32x16_bf16 v[48:63], v[112:115], v[164:167], v[48:63]
    v_exp_f32 v144, v80
    v_exp_f32 v145, v81
    v_exp_f32 v146, v82
    v_exp_f32 v147, v83
    v_mfma_f32_32x32x16_bf16 v[48:63], v[116:119], v[168:171], v[48:63]
    v_exp_f32 v148, v84
    v_exp_f32 v149, v85
    ds_read_b128 v[180:183], v219 offset:4288
    ds_read_b128 v[184:187], v219 offset:4320
    v_exp_f32 v150, v86
    v_exp_f32 v151, v87
    v_xor_b32 v229, 32, v217
    ds_read_b64_tr_b16 v[164:165], v217 offset:0
    ds_read_b64_tr_b16 v[168:169], v217 offset:1024
    ds_read_b64_tr_b16 v[166:167], v229 offset:512
    ds_read_b64_tr_b16 v[170:171], v229 offset:1536
    v_exp_f32 v152, v88
    v_exp_f32 v153, v89
    v_exp_f32 v154, v90
    v_exp_f32 v155, v91
    v_exp_f32 v156, v92
    v_exp_f32 v157, v93
    v_exp_f32 v158, v94
    v_exp_f32 v159, v95
    s_nop 1
    v_mfma_f32_32x32x16_bf16 v[144:159], v[196:199], v[196:199], v[144:159]
    s_waitcnt lgkmcnt(6)
    v_rcp_f32 v128, v128
    v_rcp_f32 v129, v129
    v_rcp_f32 v130, v130
    v_mfma_f32_32x32x16_bf16 v[96:111], v[160:163], v[208:211], 0
    v_rcp_f32 v131, v131
    v_rcp_f32 v132, v132
    v_rcp_f32 v133, v133
    v_rcp_f32 v134, v134
    v_mfma_f32_32x32x16_bf16 v[96:111], v[172:175], v[188:191], v[96:111]
    v_rcp_f32 v135, v135
    v_rcp_f32 v136, v136
    v_rcp_f32 v137, v137
    v_rcp_f32 v138, v138
    v_mfma_f32_32x32x16_bf16 v[96:111], v[176:179], v[192:195], v[96:111]
    v_rcp_f32 v139, v139
    v_rcp_f32 v140, v140
    v_rcp_f32 v141, v141
    v_rcp_f32 v142, v142
    v_rcp_f32 v143, v143
    v_pk_mul_f32 v[128:129], v[128:129], v[64:65]
    v_pk_mul_f32 v[130:131], v[130:131], v[66:67]
    v_pk_mul_f32 v[132:133], v[132:133], v[68:69]
    v_pk_mul_f32 v[134:135], v[134:135], v[70:71]
    v_pk_mul_f32 v[136:137], v[136:137], v[72:73]
    v_pk_mul_f32 v[138:139], v[138:139], v[74:75]
    v_pk_mul_f32 v[140:141], v[140:141], v[76:77]
    v_pk_mul_f32 v[142:143], v[142:143], v[78:79]
    v_cvt_pk_bf16_f32 v64, v128, v129
    v_cvt_pk_bf16_f32 v65, v130, v131
    v_cvt_pk_bf16_f32 v66, v132, v133
    v_cvt_pk_bf16_f32 v67, v134, v135
    v_cvt_pk_bf16_f32 v68, v136, v137
    v_cvt_pk_bf16_f32 v69, v138, v139
    v_cvt_pk_bf16_f32 v70, v140, v141
    v_cvt_pk_bf16_f32 v71, v142, v143
    s_waitcnt lgkmcnt(0)
    v_mfma_f32_32x32x16_bf16 v[0:15], v[64:67], v[164:167], v[0:15]
    v_exp_f32 v128, v96
    v_exp_f32 v129, v97
    v_exp_f32 v130, v98
    v_exp_f32 v131, v99
    v_mfma_f32_32x32x16_bf16 v[0:15], v[68:71], v[168:171], v[0:15]
    v_exp_f32 v132, v100
    v_exp_f32 v133, v101
    v_exp_f32 v134, v102
    v_exp_f32 v135, v103
    v_exp_f32 v136, v104
    v_exp_f32 v137, v105
    v_exp_f32 v138, v106
    v_exp_f32 v139, v107
    v_exp_f32 v140, v108
    v_exp_f32 v141, v109
    v_exp_f32 v142, v110
    v_exp_f32 v143, v111
    s_nop 1
    v_mfma_f32_32x32x16_bf16 v[128:143], v[196:199], v[196:199], v[128:143]
    v_rcp_f32 v144, v144
    v_rcp_f32 v145, v145
    v_rcp_f32 v146, v146
    v_mfma_f32_32x32x16_bf16 v[112:127], v[160:163], v[212:215], 0
    v_rcp_f32 v147, v147
    v_rcp_f32 v148, v148
    v_rcp_f32 v149, v149
    v_rcp_f32 v150, v150
    v_mfma_f32_32x32x16_bf16 v[112:127], v[180:183], v[188:191], v[112:127]
    v_rcp_f32 v151, v151
    v_rcp_f32 v152, v152
    v_rcp_f32 v153, v153
    v_rcp_f32 v154, v154
    v_mfma_f32_32x32x16_bf16 v[112:127], v[184:187], v[192:195], v[112:127]
    v_rcp_f32 v155, v155
    v_rcp_f32 v156, v156
    v_rcp_f32 v157, v157
    v_rcp_f32 v158, v158
    v_rcp_f32 v159, v159
    v_pk_mul_f32 v[144:145], v[144:145], v[80:81]
    v_pk_mul_f32 v[146:147], v[146:147], v[82:83]
    v_pk_mul_f32 v[148:149], v[148:149], v[84:85]
    v_pk_mul_f32 v[150:151], v[150:151], v[86:87]
    v_pk_mul_f32 v[152:153], v[152:153], v[88:89]
    v_pk_mul_f32 v[154:155], v[154:155], v[90:91]
    v_pk_mul_f32 v[156:157], v[156:157], v[92:93]
    v_pk_mul_f32 v[158:159], v[158:159], v[94:95]
    v_cvt_pk_bf16_f32 v80, v144, v145
    v_cvt_pk_bf16_f32 v81, v146, v147
    v_cvt_pk_bf16_f32 v82, v148, v149
    v_cvt_pk_bf16_f32 v83, v150, v151
    v_cvt_pk_bf16_f32 v84, v152, v153
    v_cvt_pk_bf16_f32 v85, v154, v155
    v_cvt_pk_bf16_f32 v86, v156, v157
    v_cvt_pk_bf16_f32 v87, v158, v159
    v_mfma_f32_32x32x16_bf16 v[16:31], v[80:83], v[164:167], v[16:31]
    v_exp_f32 v144, v112
    v_exp_f32 v145, v113
    v_exp_f32 v146, v114
    v_exp_f32 v147, v115
    v_mfma_f32_32x32x16_bf16 v[16:31], v[84:87], v[168:171], v[16:31]
    v_exp_f32 v148, v116
    v_exp_f32 v149, v117
    v_exp_f32 v150, v118
    v_exp_f32 v151, v119
    v_exp_f32 v152, v120
    v_exp_f32 v153, v121
    v_exp_f32 v154, v122
    v_exp_f32 v155, v123
    v_exp_f32 v156, v124
    v_exp_f32 v157, v125
    v_exp_f32 v158, v126
    v_exp_f32 v159, v127
    s_nop 1
    v_mfma_f32_32x32x16_bf16 v[144:159], v[196:199], v[196:199], v[144:159]
    s_cmp_eq_u32 s61, 0
    s_cbranch_scc1 .K2_NF4
    v_lshlrev_b32 v228, 4, v221
    buffer_load_dwordx4 v[64:67], v228, s[24:27], s6 offen offset:0
    buffer_load_dwordx4 v[68:71], v228, s[24:27], s6 offen offset:1024
    buffer_load_dwordx4 v[72:75], v228, s[24:27], s6 offen offset:2048
    buffer_load_dwordx4 v[76:79], v228, s[24:27], s6 offen offset:3072
    s_mul_i32 s70, s2, 10240
    s_lshl_b32 s71, s56, 5
    s_add_u32 s74, s70, s71
    s_add_u32 s75, s74, 4096
    s_add_u32 s76, s74, 8192
    buffer_load_dwordx2 v[200:201], v222, s[28:31], s74 offen
    buffer_load_dwordx2 v[202:203], v222, s[28:31], s75 offen
    buffer_load_dwordx2 v[204:205], v222, s[28:31], s76 offen
    s_mul_i32 s70, s58, 80
    v_lshl_add_u32 v216, v221, 2, s70
    ds_read_b32 v206, v216 offset:4348
    v_and_b32 v218, 32, v221
    v_add_u32 v218, 161664, v218
    s_mov_b32 s70, 0xf0f00f0f
    s_mov_b32 s71, 0xf0f00f0f
    v_cndmask_b32 v218, v223, v218, s[70:71]
    ds_read_b128 v[172:175], v218 offset:0
    ds_read_b128 v[176:179], v218 offset:16
    ds_read_b128 v[180:183], v218 offset:64
    ds_read_b128 v[184:187], v218 offset:80
    ds_read_b128 v[188:191], v218 offset:128
    ds_read_b128 v[192:195], v218 offset:144
    ds_read_b128 v[208:211], v218 offset:192
    ds_read_b128 v[212:215], v218 offset:208
.K2_NF4:
    v_rcp_f32 v128, v128
    v_rcp_f32 v129, v129
    v_rcp_f32 v130, v130
    v_rcp_f32 v131, v131
    v_rcp_f32 v132, v132
    v_rcp_f32 v133, v133
    v_rcp_f32 v134, v134
    v_rcp_f32 v135, v135
    v_rcp_f32 v136, v136
    v_rcp_f32 v137, v137
    v_rcp_f32 v138, v138
    v_rcp_f32 v139, v139
    v_rcp_f32 v140, v140
    v_rcp_f32 v141, v141
    v_rcp_f32 v142, v142
    v_rcp_f32 v143, v143
    v_pk_mul_f32 v[128:129], v[128:129], v[96:97]
    v_pk_mul_f32 v[130:131], v[130:131], v[98:99]
    v_pk_mul_f32 v[132:133], v[132:133], v[100:101]
    v_pk_mul_f32 v[134:135], v[134:135], v[102:103]
    v_pk_mul_f32 v[136:137], v[136:137], v[104:105]
    v_pk_mul_f32 v[138:139], v[138:139], v[106:107]
    v_pk_mul_f32 v[140:141], v[140:141], v[108:109]
    v_pk_mul_f32 v[142:143], v[142:143], v[110:111]
    v_cvt_pk_bf16_f32 v96, v128, v129
    v_cvt_pk_bf16_f32 v97, v130, v131
    v_cvt_pk_bf16_f32 v98, v132, v133
    v_cvt_pk_bf16_f32 v99, v134, v135
    v_cvt_pk_bf16_f32 v100, v136, v137
    v_cvt_pk_bf16_f32 v101, v138, v139
    v_cvt_pk_bf16_f32 v102, v140, v141
    v_cvt_pk_bf16_f32 v103, v142, v143
    v_mfma_f32_32x32x16_bf16 v[32:47], v[96:99], v[164:167], v[32:47]
    s_nop 0
    v_mfma_f32_32x32x16_bf16 v[32:47], v[100:103], v[168:171], v[32:47]
    v_rcp_f32 v144, v144
    v_rcp_f32 v145, v145
    v_rcp_f32 v146, v146
    v_rcp_f32 v147, v147
    v_rcp_f32 v148, v148
    v_rcp_f32 v149, v149
    v_rcp_f32 v150, v150
    v_rcp_f32 v151, v151
    v_rcp_f32 v152, v152
    v_rcp_f32 v153, v153
    v_rcp_f32 v154, v154
    v_rcp_f32 v155, v155
    v_rcp_f32 v156, v156
    v_rcp_f32 v157, v157
    v_rcp_f32 v158, v158
    v_rcp_f32 v159, v159
    v_pk_mul_f32 v[144:145], v[144:145], v[112:113]
    v_pk_mul_f32 v[146:147], v[146:147], v[114:115]
    v_pk_mul_f32 v[148:149], v[148:149], v[116:117]
    v_pk_mul_f32 v[150:151], v[150:151], v[118:119]
    v_pk_mul_f32 v[152:153], v[152:153], v[120:121]
    v_pk_mul_f32 v[154:155], v[154:155], v[122:123]
    v_pk_mul_f32 v[156:157], v[156:157], v[124:125]
    v_pk_mul_f32 v[158:159], v[158:159], v[126:127]
    v_cvt_pk_bf16_f32 v112, v144, v145
    v_cvt_pk_bf16_f32 v113, v146, v147
    v_cvt_pk_bf16_f32 v114, v148, v149
    v_cvt_pk_bf16_f32 v115, v150, v151
    v_cvt_pk_bf16_f32 v116, v152, v153
    v_cvt_pk_bf16_f32 v117, v154, v155
    v_cvt_pk_bf16_f32 v118, v156, v157
    v_cvt_pk_bf16_f32 v119, v158, v159
    v_mfma_f32_32x32x16_bf16 v[48:63], v[112:115], v[164:167], v[48:63]
    s_nop 0
    v_mfma_f32_32x32x16_bf16 v[48:63], v[116:119], v[168:171], v[48:63]
    s_branch .K2_DONE
.K2_EMPTY:
    s_cmp_eq_u32 s61, 0
    s_nop 7
    s_nop 0
    s_cbranch_scc1 .K2_SLOW_NEXT
    v_lshlrev_b32 v228, 4, v221
    buffer_load_dwordx4 v[64:67], v228, s[24:27], s6 offen offset:0
    buffer_load_dwordx4 v[68:71], v228, s[24:27], s6 offen offset:1024
    buffer_load_dwordx4 v[72:75], v228, s[24:27], s6 offen offset:2048
    buffer_load_dwordx4 v[76:79], v228, s[24:27], s6 offen offset:3072
    s_mul_i32 s70, s2, 10240
    s_lshl_b32 s71, s56, 5
    s_add_u32 s74, s70, s71
    s_add_u32 s75, s74, 4096
    s_add_u32 s76, s74, 8192
    buffer_load_dwordx2 v[200:201], v222, s[28:31], s74 offen
    buffer_load_dwordx2 v[202:203], v222, s[28:31], s75 offen
    buffer_load_dwordx2 v[204:205], v222, s[28:31], s76 offen
    s_mul_i32 s70, s58, 80
    v_lshl_add_u32 v216, v221, 2, s70
    ds_read_b32 v206, v216 offset:4348
    v_and_b32 v218, 32, v221
    v_add_u32 v218, 161664, v218
    s_mov_b32 s70, 0xf0f00f0f
    s_mov_b32 s71, 0xf0f00f0f
    v_cndmask_b32 v218, v223, v218, s[70:71]
    ds_read_b128 v[172:175], v218 offset:0
    ds_read_b128 v[176:179], v218 offset:16
    ds_read_b128 v[180:183], v218 offset:64
    ds_read_b128 v[184:187], v218 offset:80
    ds_read_b128 v[188:191], v218 offset:128
    ds_read_b128 v[192:195], v218 offset:144
    ds_read_b128 v[208:211], v218 offset:192
    ds_read_b128 v[212:215], v218 offset:208
    buffer_load_dwordx4 v[240:243], v228, s[24:27], s7 offen offset:0
    buffer_load_dwordx4 v[244:247], v228, s[24:27], s7 offen offset:1024
    buffer_load_dwordx4 v[248:251], v228, s[24:27], s7 offen offset:2048
    buffer_load_dwordx4 v[252:255], v228, s[24:27], s7 offen offset:3072
.K2_DONE:
    s_setprio 0
    s_cmp_eq_u32 s61, 0
    s_cbranch_scc1 .K2_SLOW_NEXT
    v_bfe_u32 v160, v221, 2, 3
    v_and_b32 v161, 32, v221
    s_mul_i32 s70, s58, 8272
    v_mul_u32_u24 v160, 272, v160
    s_mov_b32 s72, 0x11111
    s_mov_b32 s73, 0x11111
    v_add3_u32 v160, v160, v161, s70
    v_and_b32 v161, 15, v221
    v_lshrrev_b32 v162, 4, v221
    v_xor_b32 v163, v161, v162
    v_lshlrev_b32 v224, 8, v161
    v_lshlrev_b32 v163, 4, v163
    s_mov_b32 s70, 138496
    v_cvt_pk_bf16_f32 v128, v0, v1
    v_cvt_pk_bf16_f32 v129, v2, v3
    v_cvt_pk_bf16_f32 v130, v4, v5
    v_cvt_pk_bf16_f32 v131, v6, v7
    v_cvt_pk_bf16_f32 v132, v8, v9
    v_cvt_pk_bf16_f32 v133, v10, v11
    v_cvt_pk_bf16_f32 v134, v12, v13
    v_cvt_pk_bf16_f32 v135, v14, v15
    s_waitcnt lgkmcnt(0)
    v_mfma_f32_16x16x32_bf16 v[80:83], v[172:175], v[128:131], 0
    v_add3_u32 v164, v163, v224, s70
    v_xor_b32 v165, 64, v164
    v_xor_b32 v166, 128, v164
    v_xor_b32 v167, 192, v164
    s_mov_b64 exec, s[72:73]
    ds_write_b128 v160, v[128:131] offset:5376
    ds_write_b128 v160, v[132:135] offset:5392
    s_mov_b64 exec, -1
    ds_read_b128 v[0:3], v164 offset:0
    ds_read_b128 v[4:7], v165 offset:0
    ds_read_b128 v[8:11], v166 offset:0
    ds_read_b128 v[12:15], v167 offset:0
    v_cvt_pk_bf16_f32 v136, v16, v17
    v_cvt_pk_bf16_f32 v137, v18, v19
    v_cvt_pk_bf16_f32 v138, v20, v21
    v_cvt_pk_bf16_f32 v139, v22, v23
    v_mfma_f32_16x16x32_bf16 v[96:99], v[176:179], v[132:135], 0
    v_and_b32 v162, 48, v221
    s_movk_i32 s70, 6912
    v_mad_u32_u24 v162, v161, s63, v162
    v_add_u32 v163, 0, v161
    v_mul_u32_u24 v163, 13, v163
    v_lshrrev_b32 v163, 6, v163
    v_mad_u32_u24 v224, v163, s70, v162
    v_add_u32 v163, 16, v161
    v_mul_u32_u24 v163, 13, v163
    v_lshrrev_b32 v163, 6, v163
    v_mad_u32_u24 v225, v163, s70, v162
    v_add_u32 v163, 32, v161
    v_mul_u32_u24 v163, 13, v163
    v_lshrrev_b32 v163, 6, v163
    v_mad_u32_u24 v226, v163, s70, v162
    v_cvt_pk_bf16_f32 v140, v24, v25
    v_cvt_pk_bf16_f32 v141, v26, v27
    v_cvt_pk_bf16_f32 v142, v28, v29
    v_cvt_pk_bf16_f32 v143, v30, v31
    v_mfma_f32_16x16x32_bf16 v[80:83], v[180:183], v[136:139], v[80:83]
    s_mov_b64 exec, s[72:73]
    ds_write_b128 v160, v[136:139] offset:5440
    ds_write_b128 v160, v[140:143] offset:5456
    s_mov_b64 exec, -1
    ds_read_b128 v[16:19], v164 offset:4096
    ds_read_b128 v[20:23], v165 offset:4096
    ds_read_b128 v[24:27], v166 offset:4096
    ds_read_b128 v[28:31], v167 offset:4096
    v_cvt_pk_bf16_f32 v144, v32, v33
    v_cvt_pk_bf16_f32 v145, v34, v35
    v_cvt_pk_bf16_f32 v146, v36, v37
    v_cvt_pk_bf16_f32 v147, v38, v39
    v_mfma_f32_16x16x32_bf16 v[96:99], v[184:187], v[140:143], v[96:99]
    v_cvt_pk_bf16_f32 v148, v40, v41
    v_cvt_pk_bf16_f32 v149, v42, v43
    v_cvt_pk_bf16_f32 v150, v44, v45
    v_cvt_pk_bf16_f32 v151, v46, v47
    v_mfma_f32_16x16x32_bf16 v[80:83], v[188:191], v[144:147], v[80:83]
    s_mov_b64 exec, s[72:73]
    ds_write_b128 v160, v[144:147] offset:5504
    ds_write_b128 v160, v[148:151] offset:5520
    s_mov_b64 exec, -1
    ds_read_b128 v[32:35], v164 offset:8192
    ds_read_b128 v[36:39], v165 offset:8192
    ds_read_b128 v[40:43], v166 offset:8192
    ds_read_b128 v[44:47], v167 offset:8192
    v_cvt_pk_bf16_f32 v152, v48, v49
    v_cvt_pk_bf16_f32 v153, v50, v51
    v_cvt_pk_bf16_f32 v154, v52, v53
    v_cvt_pk_bf16_f32 v155, v54, v55
    v_mfma_f32_16x16x32_bf16 v[96:99], v[192:195], v[148:151], v[96:99]
    v_cvt_pk_bf16_f32 v156, v56, v57
    v_cvt_pk_bf16_f32 v157, v58, v59
    v_cvt_pk_bf16_f32 v158, v60, v61
    v_cvt_pk_bf16_f32 v159, v62, v63
    v_mfma_f32_16x16x32_bf16 v[80:83], v[208:211], v[152:155], v[80:83]
    s_mov_b64 exec, s[72:73]
    ds_write_b128 v160, v[152:155] offset:5568
    ds_write_b128 v160, v[156:159] offset:5584
    s_mov_b64 exec, -1
    v_mfma_f32_16x16x32_bf16 v[96:99], v[212:215], v[156:159], v[96:99]
    s_waitcnt vmcnt(0) lgkmcnt(0)
    s_barrier
    ds_read_b128 v[48:51], v224 offset:5376
    ds_read_b128 v[52:55], v224 offset:5440
    ds_read_b128 v[56:59], v224 offset:5504
    ds_read_b128 v[60:63], v224 offset:5568
    v_mfma_f32_16x16x32_bf16 v[228:231], v[64:67], v[0:3], 0
    v_mfma_f32_16x16x32_bf16 v[228:231], v[68:71], v[4:7], v[228:231]
    v_mfma_f32_16x16x32_bf16 v[228:231], v[72:75], v[8:11], v[228:231]
    v_mfma_f32_16x16x32_bf16 v[228:231], v[76:79], v[12:15], v[228:231]
    ds_read_b128 v[128:131], v225 offset:9728
    ds_read_b128 v[132:135], v225 offset:9792
    ds_read_b128 v[136:139], v225 offset:9856
    ds_read_b128 v[140:143], v225 offset:9920
    ds_read_b128 v[144:147], v226 offset:14080
    ds_read_b128 v[148:151], v226 offset:14144
    ds_read_b128 v[152:155], v226 offset:14208
    ds_read_b128 v[156:159], v226 offset:14272
    v_mfma_f32_16x16x32_bf16 v[232:235], v[64:67], v[16:19], 0
    v_mfma_f32_16x16x32_bf16 v[232:235], v[68:71], v[20:23], v[232:235]
    v_mfma_f32_16x16x32_bf16 v[232:235], v[72:75], v[24:27], v[232:235]
    v_mfma_f32_16x16x32_bf16 v[232:235], v[76:79], v[28:31], v[232:235]
    v_mfma_f32_16x16x32_bf16 v[236:239], v[64:67], v[32:35], 0
    v_mfma_f32_16x16x32_bf16 v[236:239], v[68:71], v[36:39], v[236:239]
    v_mfma_f32_16x16x32_bf16 v[236:239], v[72:75], v[40:43], v[236:239]
    v_mfma_f32_16x16x32_bf16 v[236:239], v[76:79], v[44:47], v[236:239]
    s_mov_b32 s77, 3207688728
    v_lshrrev_b32 v162, 2, v221
    v_sub_u32 v162, v221, v162
    v_lshlrev_b32 v162, 1, v162
    s_mul_i32 s70, s58, 30
    s_mul_i32 s71, s2, 240
    s_add_u32 s70, s70, s71
    s_add_u32 s70, s70, 2559998
    v_add_f32 v80, v80, v96
    s_mov_b32 s72, 0x00ff00ff
    s_mov_b32 s73, 0x00ff00ff
    v_fma_f32 v80, v80, s77, v206
    v_pk_mul_f32 v[228:229], v[228:229], s[92:93]
    v_pk_mul_f32 v[230:231], v[230:231], s[92:93]
    v_pk_mul_f32 v[232:233], v[232:233], s[92:93]
    v_pk_mul_f32 v[234:235], v[234:235], s[92:93]
    v_pk_mul_f32 v[236:237], v[236:237], s[92:93]
    v_pk_mul_f32 v[238:239], v[238:239], s[92:93]
    v_cvt_pk_bf16_f32 v80, v80, v80
    s_mov_b64 exec, 0xeeeee
    buffer_store_short v80, v162, s[36:39], s70 offen
    s_mov_b64 exec, -1
    s_waitcnt lgkmcnt(11)
    v_mfma_f32_16x16x32_bf16 v[228:231], v[240:243], v[48:51], v[228:231]
    s_waitcnt lgkmcnt(10)
    v_mfma_f32_16x16x32_bf16 v[228:231], v[244:247], v[52:55], v[228:231]
    s_waitcnt lgkmcnt(9)
    v_mfma_f32_16x16x32_bf16 v[228:231], v[248:251], v[56:59], v[228:231]
    s_waitcnt lgkmcnt(8)
    v_mfma_f32_16x16x32_bf16 v[228:231], v[252:255], v[60:63], v[228:231]
    v_lshlrev_b32 v112, 16, v200
    v_and_b32 v113, 0xffff0000, v200
    v_lshlrev_b32 v114, 16, v201
    v_and_b32 v115, 0xffff0000, v201
    v_lshlrev_b32 v116, 16, v202
    v_and_b32 v117, 0xffff0000, v202
    v_lshlrev_b32 v118, 16, v203
    v_and_b32 v119, 0xffff0000, v203
    s_waitcnt lgkmcnt(7)
    v_mfma_f32_16x16x32_bf16 v[232:235], v[240:243], v[128:131], v[232:235]
    s_waitcnt lgkmcnt(6)
    v_mfma_f32_16x16x32_bf16 v[232:235], v[244:247], v[132:135], v[232:235]
    s_waitcnt lgkmcnt(5)
    v_mfma_f32_16x16x32_bf16 v[232:235], v[248:251], v[136:139], v[232:235]
    s_waitcnt lgkmcnt(4)
    v_mfma_f32_16x16x32_bf16 v[232:235], v[252:255], v[140:143], v[232:235]
    v_lshlrev_b32 v120, 16, v204
    v_and_b32 v121, 0xffff0000, v204
    v_lshlrev_b32 v122, 16, v205
    v_and_b32 v123, 0xffff0000, v205
    v_exp_f32 v84, v228
    v_exp_f32 v85, v229
    v_exp_f32 v86, v230
    v_exp_f32 v87, v231
    s_waitcnt lgkmcnt(3)
    v_mfma_f32_16x16x32_bf16 v[236:239], v[240:243], v[144:147], v[236:239]
    s_waitcnt lgkmcnt(2)
    v_mfma_f32_16x16x32_bf16 v[236:239], v[244:247], v[148:151], v[236:239]
    s_waitcnt lgkmcnt(1)
    v_mfma_f32_16x16x32_bf16 v[236:239], v[248:251], v[152:155], v[236:239]
    s_waitcnt lgkmcnt(0)
    v_mfma_f32_16x16x32_bf16 v[236:239], v[252:255], v[156:159], v[236:239]
    v_pk_add_f32 v[84:85], v[84:85], 1.0 op_sel_hi:[1,0]
    v_pk_add_f32 v[86:87], v[86:87], 1.0 op_sel_hi:[1,0]
    v_exp_f32 v88, v232
    v_exp_f32 v89, v233
    v_exp_f32 v90, v234
    v_exp_f32 v91, v235
    v_rcp_f32 v84, v84
    v_rcp_f32 v85, v85
    v_rcp_f32 v86, v86
    v_rcp_f32 v87, v87
    v_pk_add_f32 v[88:89], v[88:89], 1.0 op_sel_hi:[1,0]
    v_pk_add_f32 v[90:91], v[90:91], 1.0 op_sel_hi:[1,0]
    v_exp_f32 v92, v236
    v_exp_f32 v93, v237
    v_exp_f32 v94, v238
    v_exp_f32 v95, v239
    v_pk_mul_f32 v[84:85], v[84:85], v[228:229]
    v_pk_mul_f32 v[86:87], v[86:87], v[230:231]
    v_fma_f32 v84, v84, s77, v112
    v_fma_f32 v85, v85, s77, v113
    v_fma_f32 v86, v86, s77, v114
    v_fma_f32 v87, v87, s77, v115
    v_cvt_pk_bf16_f32 v84, v84, v85
    v_cvt_pk_bf16_f32 v85, v86, v87
    buffer_store_dwordx2 v[84:85], v222, s[36:39], s74 offen
    v_rcp_f32 v88, v88
    v_rcp_f32 v89, v89
    v_rcp_f32 v90, v90
    v_rcp_f32 v91, v91
    v_pk_add_f32 v[92:93], v[92:93], 1.0 op_sel_hi:[1,0]
    v_pk_add_f32 v[94:95], v[94:95], 1.0 op_sel_hi:[1,0]
    v_pk_mul_f32 v[88:89], v[88:89], v[232:233]
    v_pk_mul_f32 v[90:91], v[90:91], v[234:235]
    v_fma_f32 v88, v88, s77, v116
    v_fma_f32 v89, v89, s77, v117
    v_fma_f32 v90, v90, s77, v118
    v_fma_f32 v91, v91, s77, v119
    v_cvt_pk_bf16_f32 v88, v88, v89
    v_cvt_pk_bf16_f32 v89, v90, v91
    buffer_store_dwordx2 v[88:89], v222, s[36:39], s75 offen
    v_rcp_f32 v92, v92
    v_rcp_f32 v93, v93
    v_rcp_f32 v94, v94
    v_rcp_f32 v95, v95
    v_pk_mul_f32 v[92:93], v[92:93], v[236:237]
    v_pk_mul_f32 v[94:95], v[94:95], v[238:239]
    v_fma_f32 v92, v92, s77, v120
    v_fma_f32 v93, v93, s77, v121
    v_fma_f32 v94, v94, s77, v122
    v_fma_f32 v95, v95, s77, v123
    v_cvt_pk_bf16_f32 v92, v92, v93
    v_cvt_pk_bf16_f32 v93, v94, v95
    s_mov_b64 exec, s[72:73]
    buffer_store_dwordx2 v[92:93], v222, s[36:39], s76 offen
    s_endpgm
.K2_SLOW:
    s_mov_b32 s44, s12
    s_mov_b32 s45, s13
    s_mov_b32 s46, 640000
    s_mov_b32 s47, 0x00020000
    s_mov_b32 s48, s10
    s_mov_b32 s49, s11
    s_mov_b32 s50, 640000
    s_mov_b32 s51, 0x00020000
    s_mov_b32 s52, s8
    s_mov_b32 s53, s9
    s_mov_b32 s54, 1280000
    s_mov_b32 s55, 0x00020000
    s_mov_b32 s61, 0
    s_mov_b32 s96, 0
    s_mov_b64 s[98:99], -1
    s_waitcnt vmcnt(0) lgkmcnt(0)
    s_barrier
.K2_SLOW_ZERO:
    s_lshl_b32 s70, s56, 9
    v_lshl_add_u32 v80, v221, 3, s70
    v_mov_b32 v64, 1073741824
    v_mov_b32 v65, 1073741824
    v_and_b32 v66, 248, v80
    v_mov_b32 v67, 0
    ds_write_b64 v80, v[64:65] offset:256
    ds_write2_b32 v66, v67, v67 offset0:0 offset1:1
    v_lshlrev_b32 v72, 1, v80
    v_mov_b32 v68, 0
    v_mov_b32 v69, 0
    v_mov_b32 v70, 0
    v_mov_b32 v71, 0
    ds_write_b128 v72, v[68:71] offset:5376
    ds_write_b128 v72, v[68:71] offset:13568
    ds_write_b128 v72, v[68:71] offset:21760
    ds_write_b128 v72, v[68:71] offset:29952
    ds_write_b128 v72, v[68:71] offset:38144
    ds_write_b128 v72, v[68:71] offset:46336
    ds_write_b128 v72, v[68:71] offset:54528
    ds_write_b128 v72, v[68:71] offset:62720
    v_and_b32 v74, 31, v221
    v_lshrrev_b32 v77, 5, v221
    v_bfe_u32 v78, v221, 2, 2
    v_lshlrev_b32 v74, 6, v74
    v_xor_b32 v75, v78, v77
    v_lshl_add_u32 v74, v75, 4, v74
    v_lshl_add_u32 v75, v77, 2, v78
    v_lshlrev_b32 v75, 6, v75
    v_and_b32 v76, 3, v221
    v_bfe_u32 v78, v221, 4, 1
    v_lshl_or_b32 v76, v78, 2, v76
    v_min_u32 v76, 4, v76
    v_lshl_add_u32 v76, v76, 3, 24
    v_lshlrev_b32 v77, 4, v77
    v_xor_b32 v76, v76, v77
    v_add_u32 v75, v75, v76
    v_lshrrev_b32 v76, 3, v221
    v_lshlrev_b32 v76, 4, v76
    s_lshl_b32 s70, s58, 9
    s_add_u32 s70, s70, 256
    v_add_u32 v218, s70, v76
    s_lshl_b32 s70, s58, 13
    s_add_u32 s70, s70, 5376
    v_add_u32 v216, s70, v74
    v_add_u32 v217, s70, v75
    s_waitcnt lgkmcnt(0)
    s_barrier
.K2_SLOW_BATCH:
    s_lshl_b32 s70, s56, 6
    s_add_u32 s70, s70, s96
    v_add_u32 v80, s70, v221
    v_lshlrev_b32 v81, 2, v80
    v_lshlrev_b32 v82, 3, v80
    buffer_load_dword v83, v81, s[44:47], 0 offen
    buffer_load_dword v84, v81, s[48:51], 0 offen
    buffer_load_dwordx2 v[128:129], v82, s[52:55], 0 offen
    s_mov_b32 s71, 160000
    v_cmp_gt_u32 s[80:81], s71, v80
    v_mov_b32 v88, 1
    v_mov_b32 v89, 0x3f80
    v_mov_b32 v90, 0
    s_lshl_b32 s70, s58, 2
    v_mov_b32 v72, s70
    s_waitcnt vmcnt(0)
    v_mul_u32_u24 v85, 13108, v83
    v_lshrrev_b32 v85, 16, v85
    v_mad_i32_i24 v86, v85, -5, v83
    v_lshlrev_b32 v87, 2, v85
    v_and_b32 v87, 0x1c, v87
    v_lshl_or_b32 v86, v86, 5, v87
    v_lshl_or_b32 v91, v84, 8, v86
    v_lshrrev_b32 v85, 3, v85
    v_cmp_eq_u32 vcc, s2, v85
    s_and_b64 s[80:81], s[80:81], s[98:99]
    s_and_b64 s[80:81], s[80:81], vcc
    s_mov_b64 s[98:99], s[80:81]
    v_and_b32 v134, 0x1c, v91
    s_mov_b64 exec, s[80:81]
    ds_add_rtn_u32 v133, v134, v88 offset:0
    s_mov_b64 exec, -1
    v_and_b32 v139, 0x3fff00, v91
    v_bfe_u32 v135, v91, 5, 3
    v_lshrrev_b32 v92, 4, v139
    v_mul_u32_u24 v140, 20, v134
    buffer_load_dwordx3 v[136:138], v92, s[24:27], s88 offen
    v_lshl_add_u32 v140, v135, 4, v140
    ds_read_b96 v[140:142], v140 offset:4352
    s_waitcnt lgkmcnt(0)
    v_cmp_gt_u32 vcc, s91, v133
    v_lshl_add_u32 v134, v134, 5, v133
    v_lshlrev_b32 v92, 2, v134
    s_and_b64 s[80:81], vcc, s[80:81]
    s_mov_b64 exec, s[80:81]
    ds_write_b32 v92, v139 offset:256
    s_mov_b64 exec, -1
    s_andn2_b64 s[98:99], s[98:99], s[80:81]
    v_and_b32 v139, 12, v134
    v_lshlrev_b32 v134, 6, v134
    v_lshl_add_u32 v133, v135, 1, 12
    v_lshl_or_b32 v134, v139, 2, v134
    v_lshl_add_u32 v135, v135, 3, 24
    v_xor_b32 v133, v133, v134
    v_xor_b32 v135, v135, v134
    s_waitcnt vmcnt(0)
    v_sub_f32 v136, v140, v136
    v_sub_f32 v137, v141, v137
    v_sub_f32 v138, v142, v138
    v_cvt_pk_bf16_f32 v140, 1.0, v136
    v_cvt_pk_bf16_f32 v141, v137, v138
    v_dot2_f32_bf16 v136, v140, v140, -1.0
    s_mov_b64 exec, s[80:81]
    ds_write_b16 v133, v89 offset:5376
    ds_write_b64 v135, v[140:141] offset:5376
    v_dot2_f32_bf16 v136, v141, v141, v136
    s_nop 2
    v_cvt_pk_bf16_f32 v130, v136, v136
    ds_write_b96 v134, v[128:130] offset:5376
    s_mov_b64 exec, -1
    s_waitcnt lgkmcnt(0)
    s_barrier
    ds_read_b128 v[64:67], v90 offset:0
    ds_read_b128 v[68:71], v90 offset:16
    ds_read_b32 v72, v72 offset:0
    ds_read_b128 v[224:227], v218
    s_waitcnt lgkmcnt(0)
    v_max3_u32 v64, v64, v65, v66
    v_max3_u32 v68, v68, v69, v70
    v_readfirstlane_b32 s59, v72
    v_max3_u32 v64, v64, v67, v71
    v_max_u32 v64, v64, v68
    s_min_u32 s59, s59, 128
    v_readfirstlane_b32 s97, v64
    s_barrier
    s_cmp_eq_u32 s97, 0
    s_nop 1
    s_cbranch_scc1 .K2_SLOW_ADV
    s_cmp_eq_u32 s59, 0
    s_cbranch_scc1 .K2_SLOW_NEXT
    v_add_u32 v224, v224, v220
    v_add_u32 v225, v225, v220
    v_add_u32 v226, v226, v220
    v_add_u32 v227, v227, v220
    s_mov_b32 m0, s68
    s_nop 0
    buffer_load_dwordx4 v224, s[32:35], s64 offen offset:0 lds
    buffer_load_dwordx4 v225, s[32:35], s65 offen offset:1056 lds
    buffer_load_dwordx4 v226, s[32:35], s66 offen offset:2112 lds
    buffer_load_dwordx4 v227, s[32:35], s67 offen offset:3168 lds
    s_mov_b32 m0, s57
    s_nop 0
    buffer_load_dwordx4 v224, s[32:35], s14 offen offset:0 lds
    buffer_load_dwordx4 v225, s[32:35], s15 offen offset:1056 lds
    buffer_load_dwordx4 v226, s[32:35], s16 offen offset:2112 lds
    buffer_load_dwordx4 v227, s[32:35], s17 offen offset:3168 lds
    s_waitcnt vmcnt(0)
    s_branch .K2_MAIN
.K2_SLOW_NEXT:
    s_waitcnt vmcnt(0) lgkmcnt(0)
    s_barrier
    s_cmp_gt_u32 s97, 128
    s_cbranch_scc1 .K2_SLOW_ZERO
    s_add_u32 s96, s96, 512
    s_mov_b64 s[98:99], -1
    s_cmp_lt_u32 s96, 160000
    s_cbranch_scc1 .K2_SLOW_ZERO
    s_branch .K2_SLOW_FIN
.K2_SLOW_ADV:
    s_add_u32 s96, s96, 512
    s_mov_b64 s[98:99], -1
    s_cmp_lt_u32 s96, 160000
    s_cbranch_scc1 .K2_SLOW_BATCH
.K2_SLOW_FIN:
    s_mov_b32 s61, 1
    s_mov_b32 s59, 0
    s_branch .K2_MAIN
.section .rodata,"a"
.p2align 6
.amdhsa_kernel egnn_prep_kernel
  .amdhsa_next_free_vgpr 144
  .amdhsa_next_free_sgpr 88
  .amdhsa_accum_offset 144
  .amdhsa_group_segment_fixed_size 0
  .amdhsa_kernarg_size 88
  .amdhsa_user_sgpr_count 2
  .amdhsa_user_sgpr_kernarg_segment_ptr 1
  .amdhsa_system_sgpr_workgroup_id_x 1
.end_amdhsa_kernel
.p2align 6
.amdhsa_kernel egnn_main_kernel
  .amdhsa_next_free_vgpr 256
  .amdhsa_next_free_sgpr 100
  .amdhsa_accum_offset 256
  .amdhsa_group_segment_fixed_size 0
  .amdhsa_kernarg_size 88
  .amdhsa_user_sgpr_count 2
  .amdhsa_user_sgpr_kernarg_segment_ptr 1
  .amdhsa_system_sgpr_workgroup_id_x 1
.end_amdhsa_kernel
```
